```python
import torch

def _softmax(x, axis=-1):
    return torch.softmax(x, dim=axis)
def _gelu(x):
    return torch.nn.functional.gelu(x, approximate="tanh")
def _silu(x):
    return torch.nn.functional.silu(x)
def _sigmoid(x):
    return torch.sigmoid(x)
def _layernorm(x, axis=-1, eps=1e-5):
    m = x.mean(dim=axis, keepdim=True)
    v = x.var(dim=axis, keepdim=True, unbiased=False)
    return (x - m) / torch.sqrt(v + eps)
def _scatter_add(tgt, idx, src, axis=0):
    return tgt.clone().index_add_(axis, idx, src)
def _segment_sum(src, seg, n):
    out = torch.zeros((n,) + src.shape[1:], dtype=src.dtype)
    return out.index_add_(0, seg, src)
def _pad(x, pw):
    flat = tuple(v for pair in reversed(pw) for v in pair)
    return torch.nn.functional.pad(x, flat)

kernel_name = 'sequential_preLN__sliding_block_cached__dense_activation_relu__decode'

def setup_inputs():

    _w = (lambda a: (lambda t: t.to(torch.bfloat16) if t.is_floating_point() else t)(torch.as_tensor(a)))
    def _A_setup():
        B, Sq, D = 8, 1, 640
        Hq, Hkv, Sk, Dh = 32, 32, 4096, 128
        assert Hq % Hkv == 0, (Hq, Hkv)
        return {
            "x": _w((lambda *s: torch.randn(*s, dtype=torch.bfloat16) * 0.05)(B, Sq, D)),
            "k_cache": _w((lambda *s: torch.randn(*s, dtype=torch.bfloat16) * 3.2)(B, Hkv, Sk, Dh)),
            "v_cache": _w((lambda *s: torch.randn(*s, dtype=torch.bfloat16) * 0.4)(B, Hkv, Sk, Dh)),
            "wq": _w((lambda *s: torch.randn(*s, dtype=torch.bfloat16) * 3.2)(D, Hq * Dh) * (D ** -0.5)),
            "wo": _w((lambda *s: torch.randn(*s, dtype=torch.bfloat16) * 0.4)(Hq * Dh, D) * ((Hq * Dh) ** -0.5)),
        }
    _A_in = _A_setup()

    def _B_setup():
        B, S, D, Dff = 8, 1, 640, 1728
        return {
            "x": _w((lambda *s: torch.randn(*s, dtype=torch.bfloat16) * 0.05)(B, S, D)),
            "w1": _w((lambda *s: torch.randn(*s, dtype=torch.bfloat16) * 0.05)(D, Dff)),
            "w2": _w((lambda *s: torch.randn(*s, dtype=torch.bfloat16) * 0.05)(Dff, D)),
        }
    _B_in = _B_setup()

    return {
        "A_x": _A_in["x"],
        "A_k_cache": _A_in["k_cache"],
        "A_v_cache": _A_in["v_cache"],
        "A_wq": _A_in["wq"],
        "A_wo": _A_in["wo"],
        "B_x": _B_in["x"],
        "B_w1": _B_in["w1"],
        "B_w2": _B_in["w2"],
    }

def reference(A_x, A_k_cache, A_v_cache, A_wq, A_wo, B_x, B_w1, B_w2):
    def _A_ref(x, k_cache, v_cache, wq, wo):
        B, Sq, D = x.shape
        Hq, Dh = 32, 128
        Hkv, Sk = k_cache.shape[1], k_cache.shape[2]
        W = min(4096, max(256, Sk // 4))
        rep = Hq // Hkv
        q = (lambda x, *d: x.permute(*d))((x @ wq).reshape(B, Sq, Hq, Dh), 0, 2, 1, 3)
        k = (lambda x, n, axis: torch.repeat_interleave(x, n, dim=axis))(k_cache[:, :, Sk - W:, :], rep, axis=1)
        v = (lambda x, n, axis: torch.repeat_interleave(x, n, dim=axis))(v_cache[:, :, Sk - W:, :], rep, axis=1)
        scores = torch.einsum("bhqd,bhkd->bhqk", q, k) * (Dh ** -0.5)
        p = _softmax(scores, axis=-1)
        o = torch.einsum("bhqk,bhkd->bhqd", p, v)
        return (lambda x, *d: x.permute(*d))(o, 0, 2, 1, 3).reshape(B, Sq, Hq * Dh) @ wo

    def _B_ref(x, w1, w2):
        h = torch.einsum("bsd,df->bsf", x, w1)
        zero = torch.zeros_like(h)
        h = torch.maximum(h, zero)
        return torch.einsum("bsf,fd->bsd", h, w2)

    x = A_x
    h = x + _A_ref(_layernorm(x, axis=-1), A_k_cache, A_v_cache, A_wq, A_wo)
    h2 = h + _B_ref(_layernorm(h, axis=-1), B_w1, B_w2)
    return h2
```

```asm
; @launch grid=(256,1,1) block=(512,1,1) lds=128000
.amdgcn_target "amdgcn-amd-amdhsa--gfx950"
.text
.globl sequential_preLN__sliding_block_cached__dense_activation_relu__decode_kernel
.p2align 12
.fill 192, 4, 0xbf810000
.p2align 8
.type sequential_preLN__sliding_block_cached__dense_activation_relu__decode_kernel,@function
sequential_preLN__sliding_block_cached__dense_activation_relu__decode_kernel:
  s_cmp_ge_u32 s2, 256
  s_cbranch_scc1 L_end
  s_load_dwordx16 s[4:19], s[0:1], 0
  s_load_dwordx4 s[20:23], s[0:1], 64
  s_load_dwordx2 s[24:25], s[0:1], 80
  v_and_b32 v1, 63, v0
  v_lshrrev_b32 v44, 6, v0
  v_lshrrev_b32 v45, 4, v1
  v_and_b32 v46, 15, v0
  v_readfirstlane_b32 s26, v44
  s_lshr_b32 s76, s2, 5
  s_and_b32 s77, s2, 31
  s_lshl_b32 s3, s76, 5
  s_or_b32 s3, s3, s77
  v_lshlrev_b32 v2, 4, v0
  v_lshl_add_u32 v47, v44, 2, v45
  s_lshl_b32 s84, s76, 2
  v_add_u32 v5, s84, v47
  v_and_b32 v5, 31, v5
  v_mul_u32_u24 v4, 5120, v47
  v_mov_b32 v47, v5
  v_mul_u32_u24 v47, 20, v47
  v_lshlrev_b32 v3, 13, v47
  v_lshl_add_u32 v3, v46, 4, v3
  v_lshl_add_u32 v4, v46, 4, v4
  v_mul_u32_u24 v32, 20, v1
  v_lshlrev_b32 v33, 0, v46
  v_add_lshl_u32 v33, v47, v33, 1
  v_and_b32 v34, 3, v0
  v_lshlrev_b32 v34, 0, v34
  v_add_lshl_u32 v34, v47, v34, 1
  s_mul_i32 s84, s76, 1280
  s_lshl_b32 s85, s77, 8
  s_lshl_b32 s86, s3, 20
  s_add_u32 s86, s86, 786432
  s_mov_b32 s46, 10240
  s_mov_b32 s47, 0x20000
  s_sub_u32 s38, 5242880, s85
  s_mov_b32 s39, 0x20000
  s_mov_b32 s30, 262144
  s_mov_b32 s31, 0x20000
  s_movk_i32 s68, 4096
  s_movk_i32 s69, 8192
  s_movk_i32 s70, 12288
  s_movk_i32 s71, 16384
  s_movk_i32 s72, 20480
  s_movk_i32 s73, 24576
  s_movk_i32 s74, 28672
  s_waitcnt lgkmcnt(0)
  s_mov_b32 s44, s4
  s_mov_b32 s45, s5
  s_add_u32 s36, s10, s85
  s_addc_u32 s37, s11, 0
  s_add_u32 s28, s6, s86
  s_addc_u32 s29, s7, 0
  s_cmp_ge_u32 s2, 8
  s_cbranch_scc1 L_noinit
  s_mov_b32 s48, s24
  s_mov_b32 s49, s25
  s_mov_b32 s50, 66560
  s_mov_b32 s51, 0x20000
  s_lshl_b32 s87, s2, 12
  v_lshlrev_b32 v35, 3, v0
  v_mov_b32 v36, 0
  v_mov_b32 v37, 0
  v_mov_b32 v38, -1
  v_mov_b32 v39, -1
  buffer_store_dwordx2 v[36:37], v35, s[48:51], s87 offen sc0 sc1
  s_add_u32 s87, s87, 32768
  buffer_store_dwordx2 v[38:39], v35, s[48:51], s87 offen sc0 sc1
  s_lshl_b32 s87, s2, 7
  s_add_u32 s87, s87, 65536
  v_and_b32 v35, 0x78, v35
  buffer_store_dwordx2 v[36:37], v35, s[48:51], s87 offen sc0 sc1
L_noinit:
  buffer_load_dwordx4 v[16:19], v32, s[44:47], s84 offen
  buffer_load_dword v20, v32, s[44:47], s84 offen offset:16
  buffer_load_ushort v22, v33, s[44:47], s84 offen
  buffer_load_ushort v23, v34, s[44:47], s84 offen offset:32
  buffer_load_dwordx4 v[48:51], v3, s[36:39], 0 offen
  buffer_load_dwordx4 v[52:55], v2, s[28:31], 0 offen offset:0 sc1 nt
  s_mov_b32 s78, 8192
  buffer_load_dwordx4 v[56:59], v3, s[36:39], s78 offen
  s_mov_b32 s78, 8192
  buffer_load_dwordx4 v[60:63], v2, s[28:31], s78 offen offset:0 sc1 nt
  s_mov_b32 s78, 16384
  buffer_load_dwordx4 v[64:67], v3, s[36:39], s78 offen
  s_mov_b32 s78, 16384
  buffer_load_dwordx4 v[68:71], v2, s[28:31], s78 offen offset:0 sc1 nt
  s_mov_b32 s78, 24576
  buffer_load_dwordx4 v[72:75], v2, s[28:31], s78 offen offset:0 sc1 nt
  s_mov_b32 s78, 24576
  buffer_load_dwordx4 v[76:79], v3, s[36:39], s78 offen
  s_mov_b32 s78, 32768
  buffer_load_dwordx4 v[80:83], v2, s[28:31], s78 offen offset:0 sc1 nt
  s_mov_b32 s78, 32768
  buffer_load_dwordx4 v[84:87], v3, s[36:39], s78 offen
  s_mov_b32 s78, 40960
  buffer_load_dwordx4 v[88:91], v2, s[28:31], s78 offen offset:0 sc1 nt
  s_mov_b32 s78, 49152
  buffer_load_dwordx4 v[92:95], v2, s[28:31], s78 offen offset:0 sc1 nt
  s_mov_b32 s78, 40960
  buffer_load_dwordx4 v[96:99], v3, s[36:39], s78 offen
  s_add_u32 s32, s8, s86
  s_addc_u32 s33, s9, 0
  s_mov_b32 s34, 262144
  s_mov_b32 s35, 0x20000
  s_mul_i32 s85, s77, 163840
  s_add_u32 s40, s12, s85
  s_addc_u32 s41, s13, 0
  s_mov_b32 s42, 163840
  s_mov_b32 s43, 0x20000
  s_lshl_b32 s84, s26, 15
  s_load_dword s88, s[28:29], s84
  s_load_dword s89, s[32:33], s84
  s_mul_i32 s84, s26, 20480
  s_load_dword s87, s[40:41], s84
  s_mov_b32 s48, s24
  s_mov_b32 s49, s25
  s_mov_b32 s50, 66560
  s_mov_b32 s51, 0x20000
  s_mov_b32 s56, s20
  s_mov_b32 s57, s21
  s_mov_b32 s58, 10240
  s_mov_b32 s59, 0x20000
  s_add_u32 s60, s24, 32768
  s_addc_u32 s61, s25, 0
  s_mov_b32 s62, 27648
  s_mov_b32 s63, 0x20000
  s_mov_b32 s64, s22
  s_mov_b32 s65, s23
  s_mov_b32 s66, 256
  s_mov_b32 s67, 0x20000
  s_mov_b32 s80, 0xcccccccc
  s_mov_b32 s81, 0xcccccccc
  s_mov_b32 s82, 0xaaaaaaaa
  s_mov_b32 s83, 0xaaaaaaaa
  v_and_b32 v35, 1, v0
  v_lshlrev_b32 v35, 4, v35
  v_mov_b32 v38, 0xffff
  v_lshlrev_b32 v38, v35, v38
  v_lshrrev_b32 v37, 1, v46
  v_cmp_eq_u32 vcc, 0, v37
  s_nop 1
  v_cndmask_b32 v6, 0, v38, vcc
  v_cmp_eq_u32 vcc, 1, v37
  s_nop 1
  v_cndmask_b32 v7, 0, v38, vcc
  v_cmp_eq_u32 vcc, 2, v37
  s_nop 1
  v_cndmask_b32 v8, 0, v38, vcc
  v_cmp_eq_u32 vcc, 3, v37
  s_nop 1
  v_cndmask_b32 v9, 0, v38, vcc
  v_lshlrev_b32 v47, 9, v44
  v_lshl_add_u32 v47, v46, 5, v47
  v_lshl_add_u32 v47, v45, 4, v47
  s_waitcnt vmcnt(13)
  v_lshlrev_b32 v24, 16, v16
  v_and_b32 v25, 0xffff0000, v16
  v_lshlrev_b32 v26, 16, v17
  v_and_b32 v27, 0xffff0000, v17
  v_lshlrev_b32 v28, 16, v18
  v_and_b32 v29, 0xffff0000, v18
  v_lshlrev_b32 v30, 16, v19
  v_and_b32 v31, 0xffff0000, v19
  v_lshlrev_b32 v32, 16, v20
  v_and_b32 v33, 0xffff0000, v20
  v_add_f32 v34, v24, v25
  v_add_f32 v35, v26, v27
  v_add_f32 v34, v34, v28
  v_add_f32 v35, v35, v29
  v_add_f32 v34, v34, v30
  v_add_f32 v35, v35, v31
  v_add_f32 v34, v34, v32
  v_add_f32 v35, v35, v33
  v_add_f32 v34, v34, v35
  s_nop 1
  v_add_f32_dpp v34, v34, v34 quad_perm:[1,0,3,2] row_mask:0xf bank_mask:0xf
  s_nop 1
  v_add_f32_dpp v34, v34, v34 quad_perm:[2,3,0,1] row_mask:0xf bank_mask:0xf
  s_nop 1
  v_add_f32_dpp v34, v34, v34 row_half_mirror row_mask:0xf bank_mask:0xf
  s_nop 1
  v_add_f32_dpp v34, v34, v34 row_mirror row_mask:0xf bank_mask:0xf
  s_nop 1
  v_add_f32_dpp v34, v34, v34 row_bcast:15 row_mask:0xa bank_mask:0xf
  s_nop 1
  v_add_f32_dpp v34, v34, v34 row_bcast:31 row_mask:0xc bank_mask:0xf
  s_nop 0
  v_readlane_b32 s84, v34, 63
  v_mov_b32 v37, 0x3acccccd
  s_nop 0
  v_mul_f32 v38, s84, v37
  v_sub_f32 v35, v24, v38
  v_mul_f32 v34, v35, v35
  v_sub_f32 v35, v25, v38
  v_fmac_f32 v34, v35, v35
  v_sub_f32 v35, v26, v38
  v_fmac_f32 v34, v35, v35
  v_sub_f32 v35, v27, v38
  v_fmac_f32 v34, v35, v35
  v_sub_f32 v35, v28, v38
  v_fmac_f32 v34, v35, v35
  v_sub_f32 v35, v29, v38
  v_fmac_f32 v34, v35, v35
  v_sub_f32 v35, v30, v38
  v_fmac_f32 v34, v35, v35
  v_sub_f32 v35, v31, v38
  v_fmac_f32 v34, v35, v35
  v_sub_f32 v35, v32, v38
  v_fmac_f32 v34, v35, v35
  v_sub_f32 v35, v33, v38
  v_fmac_f32 v34, v35, v35
  s_nop 1
  v_add_f32_dpp v34, v34, v34 quad_perm:[1,0,3,2] row_mask:0xf bank_mask:0xf
  s_nop 1
  v_add_f32_dpp v34, v34, v34 quad_perm:[2,3,0,1] row_mask:0xf bank_mask:0xf
  s_nop 1
  v_add_f32_dpp v34, v34, v34 row_half_mirror row_mask:0xf bank_mask:0xf
  s_nop 1
  v_add_f32_dpp v34, v34, v34 row_mirror row_mask:0xf bank_mask:0xf
  s_nop 1
  v_add_f32_dpp v34, v34, v34 row_bcast:15 row_mask:0xa bank_mask:0xf
  s_nop 1
  v_add_f32_dpp v34, v34, v34 row_bcast:31 row_mask:0xc bank_mask:0xf
  s_nop 0
  v_readlane_b32 s84, v34, 63
  s_nop 1
  v_mul_f32 v34, s84, v37
  v_cvt_pk_bf16_f32 v34, v34, v38
  v_and_b32 v38, 0xffff0000, v34
  v_lshlrev_b32 v34, 16, v34
  v_add_f32 v34, 0x3727c5ac, v34
  v_cvt_pk_bf16_f32 v34, v34, v34
  v_lshlrev_b32 v34, 16, v34
  v_sqrt_f32 v34, v34
  s_nop 0
  v_cvt_pk_bf16_f32 v34, v34, v34
  v_lshlrev_b32 v34, 16, v34
  v_rcp_f32 v39, v34
  v_lshlrev_b32 v22, 16, v22
  v_sub_f32 v22, v22, v38
  v_cvt_pk_bf16_f32 v22, v22, v22
  v_lshlrev_b32 v22, 16, v22
  v_mul_f32 v22, v22, v39
  v_cvt_pk_bf16_f32 v22, v22, v22
  v_lshlrev_b32 v23, 16, v23
  v_sub_f32 v23, v23, v38
  v_cvt_pk_bf16_f32 v23, v23, v23
  v_lshlrev_b32 v23, 16, v23
  v_mul_f32 v23, v23, v39
  v_cvt_pk_bf16_f32 v23, v23, v23
  v_and_b32_dpp v24, v22, v6 row_newbcast:0 row_mask:0xf bank_mask:0xf
  v_and_b32_dpp v25, v22, v7 row_newbcast:0 row_mask:0xf bank_mask:0xf
  v_and_b32_dpp v26, v22, v8 row_newbcast:0 row_mask:0xf bank_mask:0xf
  v_and_b32_dpp v27, v22, v9 row_newbcast:0 row_mask:0xf bank_mask:0xf
  s_waitcnt vmcnt(12)
  s_nop 0
  v_mfma_f32_16x16x32_bf16 v[40:43], v[24:27], v[48:51], 0
  v_and_b32_dpp v28, v22, v6 row_newbcast:1 row_mask:0xf bank_mask:0xf
  v_and_b32_dpp v29, v22, v7 row_newbcast:1 row_mask:0xf bank_mask:0xf
  v_and_b32_dpp v30, v22, v8 row_newbcast:1 row_mask:0xf bank_mask:0xf
  v_and_b32_dpp v31, v22, v9 row_newbcast:1 row_mask:0xf bank_mask:0xf
  s_mov_b32 s78, 57344
  buffer_load_dwordx4 v[100:103], v2, s[28:31], s78 offen offset:0 sc1 nt
  s_mov_b32 s78, 49152
  buffer_load_dwordx4 v[104:107], v3, s[36:39], s78 offen
  s_waitcnt vmcnt(12)
  v_mfma_f32_16x16x32_bf16 v[40:43], v[28:31], v[56:59], v[40:43]
  v_and_b32_dpp v24, v22, v6 row_newbcast:2 row_mask:0xf bank_mask:0xf
  v_and_b32_dpp v25, v22, v7 row_newbcast:2 row_mask:0xf bank_mask:0xf
  v_and_b32_dpp v26, v22, v8 row_newbcast:2 row_mask:0xf bank_mask:0xf
  v_and_b32_dpp v27, v22, v9 row_newbcast:2 row_mask:0xf bank_mask:0xf
  s_mov_b32 s78, 65536
  buffer_load_dwordx4 v[108:111], v2, s[28:31], s78 offen offset:0 sc1 nt
  s_mov_b32 s78, 57344
  buffer_load_dwordx4 v[112:115], v3, s[36:39], s78 offen
  s_waitcnt vmcnt(12)
  v_mfma_f32_16x16x32_bf16 v[40:43], v[24:27], v[64:67], v[40:43]
  v_and_b32_dpp v28, v22, v6 row_newbcast:3 row_mask:0xf bank_mask:0xf
  v_and_b32_dpp v29, v22, v7 row_newbcast:3 row_mask:0xf bank_mask:0xf
  v_and_b32_dpp v30, v22, v8 row_newbcast:3 row_mask:0xf bank_mask:0xf
  v_and_b32_dpp v31, v22, v9 row_newbcast:3 row_mask:0xf bank_mask:0xf
  s_mov_b32 s78, 73728
  buffer_load_dwordx4 v[116:119], v2, s[28:31], s78 offen offset:0 sc1 nt
  s_mov_b32 s78, 81920
  buffer_load_dwordx4 v[120:123], v2, s[28:31], s78 offen offset:0 sc1 nt
  s_mov_b32 s78, 65536
  buffer_load_dwordx4 v[124:127], v3, s[36:39], s78 offen
  s_waitcnt vmcnt(12)
  v_mfma_f32_16x16x32_bf16 v[40:43], v[28:31], v[76:79], v[40:43]
  v_and_b32_dpp v24, v22, v6 row_newbcast:4 row_mask:0xf bank_mask:0xf
  v_and_b32_dpp v25, v22, v7 row_newbcast:4 row_mask:0xf bank_mask:0xf
  v_and_b32_dpp v26, v22, v8 row_newbcast:4 row_mask:0xf bank_mask:0xf
  v_and_b32_dpp v27, v22, v9 row_newbcast:4 row_mask:0xf bank_mask:0xf
  s_mov_b32 s78, 90112
  buffer_load_dwordx4 v[128:131], v2, s[28:31], s78 offen offset:0 sc1 nt
  s_mov_b32 s78, 73728
  buffer_load_dwordx4 v[132:135], v3, s[36:39], s78 offen
  s_waitcnt vmcnt(12)
  v_mfma_f32_16x16x32_bf16 v[40:43], v[24:27], v[84:87], v[40:43]
  v_and_b32_dpp v28, v22, v6 row_newbcast:5 row_mask:0xf bank_mask:0xf
  v_and_b32_dpp v29, v22, v7 row_newbcast:5 row_mask:0xf bank_mask:0xf
  v_and_b32_dpp v30, v22, v8 row_newbcast:5 row_mask:0xf bank_mask:0xf
  v_and_b32_dpp v31, v22, v9 row_newbcast:5 row_mask:0xf bank_mask:0xf
  s_mov_b32 s78, 98304
  buffer_load_dwordx4 v[136:139], v2, s[28:31], s78 offen offset:0 sc1 nt
  s_mov_b32 s78, 106496
  buffer_load_dwordx4 v[140:143], v2, s[28:31], s78 offen offset:0 sc1 nt
  s_mov_b32 s78, 81920
  buffer_load_dwordx4 v[144:147], v3, s[36:39], s78 offen
  s_waitcnt vmcnt(12)
  v_mfma_f32_16x16x32_bf16 v[40:43], v[28:31], v[96:99], v[40:43]
  v_and_b32_dpp v24, v22, v6 row_newbcast:6 row_mask:0xf bank_mask:0xf
  v_and_b32_dpp v25, v22, v7 row_newbcast:6 row_mask:0xf bank_mask:0xf
  v_and_b32_dpp v26, v22, v8 row_newbcast:6 row_mask:0xf bank_mask:0xf
  v_and_b32_dpp v27, v22, v9 row_newbcast:6 row_mask:0xf bank_mask:0xf
  s_mov_b32 s78, 114688
  buffer_load_dwordx4 v[148:151], v2, s[28:31], s78 offen offset:0 sc1 nt
  s_mov_b32 s78, 90112
  buffer_load_dwordx4 v[152:155], v3, s[36:39], s78 offen
  s_waitcnt vmcnt(12)
  v_mfma_f32_16x16x32_bf16 v[40:43], v[24:27], v[104:107], v[40:43]
  v_and_b32_dpp v28, v22, v6 row_newbcast:7 row_mask:0xf bank_mask:0xf
  v_and_b32_dpp v29, v22, v7 row_newbcast:7 row_mask:0xf bank_mask:0xf
  v_and_b32_dpp v30, v22, v8 row_newbcast:7 row_mask:0xf bank_mask:0xf
  v_and_b32_dpp v31, v22, v9 row_newbcast:7 row_mask:0xf bank_mask:0xf
  s_mov_b32 s78, 122880
  buffer_load_dwordx4 v[156:159], v2, s[28:31], s78 offen offset:0 sc1 nt
  s_mov_b32 s78, 98304
  buffer_load_dwordx4 v[160:163], v3, s[36:39], s78 offen
  s_waitcnt vmcnt(12)
  v_mfma_f32_16x16x32_bf16 v[40:43], v[28:31], v[112:115], v[40:43]
  v_and_b32_dpp v24, v22, v6 row_newbcast:8 row_mask:0xf bank_mask:0xf
  v_and_b32_dpp v25, v22, v7 row_newbcast:8 row_mask:0xf bank_mask:0xf
  v_and_b32_dpp v26, v22, v8 row_newbcast:8 row_mask:0xf bank_mask:0xf
  v_and_b32_dpp v27, v22, v9 row_newbcast:8 row_mask:0xf bank_mask:0xf
  s_mov_b32 s78, 131072
  buffer_load_dwordx4 v[164:167], v2, s[28:31], s78 offen offset:0 sc1 nt
  s_mov_b32 s78, 139264
  buffer_load_dwordx4 v[168:171], v2, s[28:31], s78 offen offset:0 sc1 nt
  s_mov_b32 s78, 106496
  buffer_load_dwordx4 v[172:175], v3, s[36:39], s78 offen
  s_waitcnt vmcnt(12)
  v_mfma_f32_16x16x32_bf16 v[40:43], v[24:27], v[124:127], v[40:43]
  v_and_b32_dpp v28, v22, v6 row_newbcast:9 row_mask:0xf bank_mask:0xf
  v_and_b32_dpp v29, v22, v7 row_newbcast:9 row_mask:0xf bank_mask:0xf
  v_and_b32_dpp v30, v22, v8 row_newbcast:9 row_mask:0xf bank_mask:0xf
  v_and_b32_dpp v31, v22, v9 row_newbcast:9 row_mask:0xf bank_mask:0xf
  s_mov_b32 s78, 147456
  buffer_load_dwordx4 v[48:51], v2, s[28:31], s78 offen offset:0 sc1 nt
  s_mov_b32 s78, 114688
  buffer_load_dwordx4 v[56:59], v3, s[36:39], s78 offen
  s_waitcnt vmcnt(12)
  v_mfma_f32_16x16x32_bf16 v[40:43], v[28:31], v[132:135], v[40:43]
  v_and_b32_dpp v24, v22, v6 row_newbcast:10 row_mask:0xf bank_mask:0xf
  v_and_b32_dpp v25, v22, v7 row_newbcast:10 row_mask:0xf bank_mask:0xf
  v_and_b32_dpp v26, v22, v8 row_newbcast:10 row_mask:0xf bank_mask:0xf
  v_and_b32_dpp v27, v22, v9 row_newbcast:10 row_mask:0xf bank_mask:0xf
  s_mov_b32 s78, 155648
  buffer_load_dwordx4 v[64:67], v2, s[28:31], s78 offen offset:0 sc1 nt
  s_mov_b32 s78, 163840
  buffer_load_dwordx4 v[76:79], v2, s[28:31], s78 offen offset:0 sc1 nt
  s_mov_b32 s78, 122880
  buffer_load_dwordx4 v[84:87], v3, s[36:39], s78 offen
  s_waitcnt vmcnt(12)
  v_mfma_f32_16x16x32_bf16 v[40:43], v[24:27], v[144:147], v[40:43]
  v_and_b32_dpp v28, v22, v6 row_newbcast:11 row_mask:0xf bank_mask:0xf
  v_and_b32_dpp v29, v22, v7 row_newbcast:11 row_mask:0xf bank_mask:0xf
  v_and_b32_dpp v30, v22, v8 row_newbcast:11 row_mask:0xf bank_mask:0xf
  v_and_b32_dpp v31, v22, v9 row_newbcast:11 row_mask:0xf bank_mask:0xf
  s_mov_b32 s78, 172032
  buffer_load_dwordx4 v[96:99], v2, s[28:31], s78 offen offset:0 sc1 nt
  s_mov_b32 s78, 131072
  buffer_load_dwordx4 v[104:107], v3, s[36:39], s78 offen
  s_waitcnt vmcnt(12)
  v_mfma_f32_16x16x32_bf16 v[40:43], v[28:31], v[152:155], v[40:43]
  v_and_b32_dpp v24, v22, v6 row_newbcast:12 row_mask:0xf bank_mask:0xf
  v_and_b32_dpp v25, v22, v7 row_newbcast:12 row_mask:0xf bank_mask:0xf
  v_and_b32_dpp v26, v22, v8 row_newbcast:12 row_mask:0xf bank_mask:0xf
  v_and_b32_dpp v27, v22, v9 row_newbcast:12 row_mask:0xf bank_mask:0xf
  s_mov_b32 s78, 180224
  buffer_load_dwordx4 v[112:115], v2, s[28:31], s78 offen offset:0 sc1 nt
  s_mov_b32 s78, 139264
  buffer_load_dwordx4 v[124:127], v3, s[36:39], s78 offen
  s_waitcnt vmcnt(12)
  v_mfma_f32_16x16x32_bf16 v[40:43], v[24:27], v[160:163], v[40:43]
  v_and_b32_dpp v28, v22, v6 row_newbcast:13 row_mask:0xf bank_mask:0xf
  v_and_b32_dpp v29, v22, v7 row_newbcast:13 row_mask:0xf bank_mask:0xf
  v_and_b32_dpp v30, v22, v8 row_newbcast:13 row_mask:0xf bank_mask:0xf
  v_and_b32_dpp v31, v22, v9 row_newbcast:13 row_mask:0xf bank_mask:0xf
  s_mov_b32 s78, 188416
  buffer_load_dwordx4 v[132:135], v2, s[28:31], s78 offen offset:0 sc1 nt
  s_mov_b32 s78, 196608
  buffer_load_dwordx4 v[144:147], v2, s[28:31], s78 offen offset:0 sc1 nt
  s_mov_b32 s78, 147456
  buffer_load_dwordx4 v[152:155], v3, s[36:39], s78 offen
  s_waitcnt vmcnt(12)
  v_mfma_f32_16x16x32_bf16 v[40:43], v[28:31], v[172:175], v[40:43]
  v_and_b32_dpp v24, v22, v6 row_newbcast:14 row_mask:0xf bank_mask:0xf
  v_and_b32_dpp v25, v22, v7 row_newbcast:14 row_mask:0xf bank_mask:0xf
  v_and_b32_dpp v26, v22, v8 row_newbcast:14 row_mask:0xf bank_mask:0xf
  v_and_b32_dpp v27, v22, v9 row_newbcast:14 row_mask:0xf bank_mask:0xf
  s_mov_b32 s78, 204800
  buffer_load_dwordx4 v[160:163], v2, s[28:31], s78 offen offset:0 sc1 nt
  s_mov_b32 s78, 155648
  buffer_load_dwordx4 v[172:175], v3, s[36:39], s78 offen
  s_waitcnt vmcnt(12)
  v_mfma_f32_16x16x32_bf16 v[40:43], v[24:27], v[56:59], v[40:43]
  v_and_b32_dpp v28, v22, v6 row_newbcast:15 row_mask:0xf bank_mask:0xf
  v_and_b32_dpp v29, v22, v7 row_newbcast:15 row_mask:0xf bank_mask:0xf
  v_and_b32_dpp v30, v22, v8 row_newbcast:15 row_mask:0xf bank_mask:0xf
  v_and_b32_dpp v31, v22, v9 row_newbcast:15 row_mask:0xf bank_mask:0xf
  s_mov_b32 s78, 212992
  buffer_load_dwordx4 v[56:59], v2, s[28:31], s78 offen offset:0 sc1 nt
  s_mov_b32 s78, 221184
  buffer_load_dwordx4 v[252:255], v2, s[28:31], s78 offen offset:0 sc1 nt
  s_mov_b32 s78, 229376
  buffer_load_dwordx4 v[248:251], v2, s[28:31], s78 offen offset:0 sc1 nt
  s_waitcnt vmcnt(12)
  v_mfma_f32_16x16x32_bf16 v[40:43], v[28:31], v[84:87], v[40:43]
  v_and_b32_dpp v24, v23, v6 row_newbcast:0 row_mask:0xf bank_mask:0xf
  v_and_b32_dpp v25, v23, v7 row_newbcast:0 row_mask:0xf bank_mask:0xf
  v_and_b32_dpp v26, v23, v8 row_newbcast:0 row_mask:0xf bank_mask:0xf
  v_and_b32_dpp v27, v23, v9 row_newbcast:0 row_mask:0xf bank_mask:0xf
  s_mov_b32 s78, 237568
  buffer_load_dwordx4 v[84:87], v2, s[28:31], s78 offen offset:0 sc1 nt
  buffer_load_dwordx4 v[176:179], v4, s[40:43], 0 offen offset:0
  s_waitcnt vmcnt(12)
  v_mfma_f32_16x16x32_bf16 v[40:43], v[24:27], v[104:107], v[40:43]
  v_and_b32_dpp v28, v23, v6 row_newbcast:1 row_mask:0xf bank_mask:0xf
  v_and_b32_dpp v29, v23, v7 row_newbcast:1 row_mask:0xf bank_mask:0xf
  v_and_b32_dpp v30, v23, v8 row_newbcast:1 row_mask:0xf bank_mask:0xf
  v_and_b32_dpp v31, v23, v9 row_newbcast:1 row_mask:0xf bank_mask:0xf
  s_mov_b32 s78, 245760
  buffer_load_dwordx4 v[104:107], v2, s[28:31], s78 offen offset:0 sc1 nt
  buffer_load_dwordx4 v[180:183], v4, s[40:43], 0 offen offset:256
  s_waitcnt vmcnt(12)
  v_mfma_f32_16x16x32_bf16 v[40:43], v[28:31], v[124:127], v[40:43]
  v_and_b32_dpp v24, v23, v6 row_newbcast:2 row_mask:0xf bank_mask:0xf
  v_and_b32_dpp v25, v23, v7 row_newbcast:2 row_mask:0xf bank_mask:0xf
  v_and_b32_dpp v26, v23, v8 row_newbcast:2 row_mask:0xf bank_mask:0xf
  v_and_b32_dpp v27, v23, v9 row_newbcast:2 row_mask:0xf bank_mask:0xf
  s_mov_b32 s78, 253952
  buffer_load_dwordx4 v[124:127], v2, s[28:31], s78 offen offset:0 sc1 nt
  s_waitcnt vmcnt(10)
  v_mfma_f32_16x16x32_bf16 v[40:43], v[24:27], v[152:155], v[40:43]
  v_and_b32_dpp v28, v23, v6 row_newbcast:3 row_mask:0xf bank_mask:0xf
  v_and_b32_dpp v29, v23, v7 row_newbcast:3 row_mask:0xf bank_mask:0xf
  v_and_b32_dpp v30, v23, v8 row_newbcast:3 row_mask:0xf bank_mask:0xf
  v_and_b32_dpp v31, v23, v9 row_newbcast:3 row_mask:0xf bank_mask:0xf
  buffer_load_dwordx4 v[152:155], v2, s[32:35], 0 offen offset:0 sc1 nt
  buffer_load_dwordx4 v[184:187], v4, s[40:43], 0 offen offset:512
  s_waitcnt vmcnt(10)
  v_mfma_f32_16x16x32_bf16 v[40:43], v[28:31], v[172:175], v[40:43]
  s_mov_b32 exec_hi, 0
  s_nop 6
  ds_write_b128 v47, v[40:43] offset:0
  s_mov_b64 exec, -1
  v_lshlrev_b32 v25, 3, v1
  s_waitcnt lgkmcnt(0)
  s_barrier
  s_cmp_ge_u32 s2, 8
  s_cbranch_scc1 L_nosig
  s_cmp_lg_u32 s26, 0
  s_cbranch_scc1 L_nosig
  v_mov_b32 v26, 0
  v_mov_b32 v27, 1
  s_mov_b64 exec, 1
  buffer_atomic_add v27, v26, s[64:67], 0 offen sc1
  s_mov_b64 exec, -1
L_nosig:
  ds_read_b64 v[28:29], v25 offset:0
  ds_read_b64 v[30:31], v25 offset:512
  ds_read_b64 v[32:33], v25 offset:1024
  ds_read_b64 v[34:35], v25 offset:1536
  ds_read_b64 v[36:37], v25 offset:2048
  ds_read_b64 v[38:39], v25 offset:2560
  ds_read_b64 v[40:41], v25 offset:3072
  ds_read_b64 v[42:43], v25 offset:3584
  s_waitcnt lgkmcnt(0)
  v_add_f32 v28, v28, v30
  v_add_f32 v29, v29, v31
  v_add_f32 v28, v28, v32
  v_add_f32 v29, v29, v33
  v_add_f32 v28, v28, v34
  v_add_f32 v29, v29, v35
  v_add_f32 v28, v28, v36
  v_add_f32 v29, v29, v37
  v_add_f32 v28, v28, v38
  v_add_f32 v29, v29, v39
  v_add_f32 v28, v28, v40
  v_add_f32 v29, v29, v41
  v_add_f32 v28, v28, v42
  v_add_f32 v29, v29, v43
  v_cvt_pk_bf16_f32 v28, v28, v29
  v_lshlrev_b32 v25, 2, v0
  ds_write_b32 v25, v28 offset:4096
  v_lshlrev_b32 v25, 8, v44
  v_lshl_add_u32 v25, v46, 4, v25
  s_waitcnt lgkmcnt(0)
  ds_read_b128 v[10:13], v25 offset:4096
  s_waitcnt lgkmcnt(0)
  s_mov_b32 s78, 8192
  buffer_load_dwordx4 v[172:175], v2, s[32:35], s78 offen offset:0 sc1 nt
  buffer_load_dwordx4 v[188:191], v4, s[40:43], 0 offen offset:768
  s_waitcnt vmcnt(56)
  v_dot2_f32_bf16 v16, v52, v10, 0
  v_dot2_f32_bf16 v16, v53, v11, v16
  v_dot2_f32_bf16 v16, v54, v12, v16
  v_dot2_f32_bf16 v16, v55, v13, v16
  s_waitcnt vmcnt(54)
  v_dot2_f32_bf16 v17, v60, v10, 0
  v_dot2_f32_bf16 v17, v61, v11, v17
  v_dot2_f32_bf16 v17, v62, v12, v17
  v_dot2_f32_bf16 v17, v63, v13, v17
  s_waitcnt vmcnt(52)
  v_dot2_f32_bf16 v18, v68, v10, 0
  v_dot2_f32_bf16 v18, v69, v11, v18
  v_dot2_f32_bf16 v18, v70, v12, v18
  v_dot2_f32_bf16 v18, v71, v13, v18
  s_mov_b32 s78, 16384
  buffer_load_dwordx4 v[52:55], v2, s[32:35], s78 offen offset:0 sc1 nt
  s_waitcnt vmcnt(52)
  v_dot2_f32_bf16 v19, v72, v10, 0
  v_dot2_f32_bf16 v19, v73, v11, v19
  v_dot2_f32_bf16 v19, v74, v12, v19
  v_dot2_f32_bf16 v19, v75, v13, v19
  s_waitcnt vmcnt(50)
  v_dot2_f32_bf16 v20, v80, v10, 0
  v_dot2_f32_bf16 v20, v81, v11, v20
  v_dot2_f32_bf16 v20, v82, v12, v20
  v_dot2_f32_bf16 v20, v83, v13, v20
  s_waitcnt vmcnt(48)
  v_dot2_f32_bf16 v21, v88, v10, 0
  v_dot2_f32_bf16 v21, v89, v11, v21
  v_dot2_f32_bf16 v21, v90, v12, v21
  v_dot2_f32_bf16 v21, v91, v13, v21
  s_mov_b32 s78, 24576
  buffer_load_dwordx4 v[60:63], v2, s[32:35], s78 offen offset:0 sc1 nt
  s_waitcnt vmcnt(48)
  v_dot2_f32_bf16 v22, v92, v10, 0
  v_dot2_f32_bf16 v22, v93, v11, v22
  v_dot2_f32_bf16 v22, v94, v12, v22
  v_dot2_f32_bf16 v22, v95, v13, v22
  s_waitcnt vmcnt(46)
  v_dot2_f32_bf16 v23, v100, v10, 0
  v_dot2_f32_bf16 v23, v101, v11, v23
  v_dot2_f32_bf16 v23, v102, v12, v23
  v_dot2_f32_bf16 v23, v103, v13, v23
  s_waitcnt vmcnt(44)
  v_dot2_f32_bf16 v24, v108, v10, 0
  v_dot2_f32_bf16 v24, v109, v11, v24
  v_dot2_f32_bf16 v24, v110, v12, v24
  v_dot2_f32_bf16 v24, v111, v13, v24
  buffer_load_dwordx4 v[192:195], v4, s[40:43], 0 offen offset:1024
  s_waitcnt vmcnt(43)
  v_dot2_f32_bf16 v25, v116, v10, 0
  v_dot2_f32_bf16 v25, v117, v11, v25
  v_dot2_f32_bf16 v25, v118, v12, v25
  v_dot2_f32_bf16 v25, v119, v13, v25
  s_waitcnt vmcnt(42)
  v_dot2_f32_bf16 v26, v120, v10, 0
  v_dot2_f32_bf16 v26, v121, v11, v26
  v_dot2_f32_bf16 v26, v122, v12, v26
  v_dot2_f32_bf16 v26, v123, v13, v26
  s_waitcnt vmcnt(40)
  v_dot2_f32_bf16 v27, v128, v10, 0
  v_dot2_f32_bf16 v27, v129, v11, v27
  v_dot2_f32_bf16 v27, v130, v12, v27
  v_dot2_f32_bf16 v27, v131, v13, v27
  s_mov_b32 s78, 32768
  buffer_load_dwordx4 v[68:71], v2, s[32:35], s78 offen offset:0 sc1 nt
  s_waitcnt vmcnt(39)
  v_dot2_f32_bf16 v28, v136, v10, 0
  v_dot2_f32_bf16 v28, v137, v11, v28
  v_dot2_f32_bf16 v28, v138, v12, v28
  v_dot2_f32_bf16 v28, v139, v13, v28
  s_waitcnt vmcnt(38)
  v_dot2_f32_bf16 v29, v140, v10, 0
  v_dot2_f32_bf16 v29, v141, v11, v29
  v_dot2_f32_bf16 v29, v142, v12, v29
  v_dot2_f32_bf16 v29, v143, v13, v29
  s_waitcnt vmcnt(36)
  v_dot2_f32_bf16 v30, v148, v10, 0
  v_dot2_f32_bf16 v30, v149, v11, v30
  v_dot2_f32_bf16 v30, v150, v12, v30
  v_dot2_f32_bf16 v30, v151, v13, v30
  s_mov_b32 s78, 40960
  buffer_load_dwordx4 v[72:75], v2, s[32:35], s78 offen offset:0 sc1 nt
  s_waitcnt vmcnt(35)
  v_dot2_f32_bf16 v31, v156, v10, 0
  v_dot2_f32_bf16 v31, v157, v11, v31
  v_dot2_f32_bf16 v31, v158, v12, v31
  v_dot2_f32_bf16 v31, v159, v13, v31
  v_add_f32_dpp v16, v16, v16 row_mirror row_mask:0xf bank_mask:0x3
  v_add_f32_dpp v17, v17, v17 row_mirror row_mask:0xf bank_mask:0x3
  v_add_f32_dpp v18, v18, v18 row_mirror row_mask:0xf bank_mask:0x3
  v_add_f32_dpp v19, v19, v19 row_mirror row_mask:0xf bank_mask:0x3
  v_add_f32_dpp v20, v20, v20 row_mirror row_mask:0xf bank_mask:0x3
  v_add_f32_dpp v21, v21, v21 row_mirror row_mask:0xf bank_mask:0x3
  v_add_f32_dpp v22, v22, v22 row_mirror row_mask:0xf bank_mask:0x3
  v_add_f32_dpp v23, v23, v23 row_mirror row_mask:0xf bank_mask:0x3
  v_add_f32_dpp v16, v24, v24 row_mirror row_mask:0xf bank_mask:0xc
  v_add_f32_dpp v17, v25, v25 row_mirror row_mask:0xf bank_mask:0xc
  v_add_f32_dpp v18, v26, v26 row_mirror row_mask:0xf bank_mask:0xc
  v_add_f32_dpp v19, v27, v27 row_mirror row_mask:0xf bank_mask:0xc
  v_add_f32_dpp v20, v28, v28 row_mirror row_mask:0xf bank_mask:0xc
  v_add_f32_dpp v21, v29, v29 row_mirror row_mask:0xf bank_mask:0xc
  v_add_f32_dpp v22, v30, v30 row_mirror row_mask:0xf bank_mask:0xc
  v_add_f32_dpp v23, v31, v31 row_mirror row_mask:0xf bank_mask:0xc
  v_add_f32_dpp v16, v16, v16 row_half_mirror row_mask:0xf bank_mask:0x5
  v_add_f32_dpp v17, v17, v17 row_half_mirror row_mask:0xf bank_mask:0x5
  v_add_f32_dpp v18, v18, v18 row_half_mirror row_mask:0xf bank_mask:0x5
  v_add_f32_dpp v19, v19, v19 row_half_mirror row_mask:0xf bank_mask:0x5
  v_add_f32_dpp v16, v20, v20 row_half_mirror row_mask:0xf bank_mask:0xa
  v_add_f32_dpp v17, v21, v21 row_half_mirror row_mask:0xf bank_mask:0xa
  v_add_f32_dpp v18, v22, v22 row_half_mirror row_mask:0xf bank_mask:0xa
  v_add_f32_dpp v19, v23, v23 row_half_mirror row_mask:0xf bank_mask:0xa
  v_add_f32_dpp v16, v16, v16 quad_perm:[3,2,1,0] row_mask:0xf bank_mask:0xf
  v_add_f32_dpp v17, v17, v17 quad_perm:[3,2,1,0] row_mask:0xf bank_mask:0xf
  v_add_f32_dpp v18, v18, v18 quad_perm:[3,2,1,0] row_mask:0xf bank_mask:0xf
  v_add_f32_dpp v19, v19, v19 quad_perm:[3,2,1,0] row_mask:0xf bank_mask:0xf
  v_cndmask_b32 v16, v16, v18, s[80:81]
  v_cndmask_b32 v17, v17, v19, s[80:81]
  s_nop 0
  v_add_f32_dpp v16, v16, v16 quad_perm:[1,0,3,2] row_mask:0xf bank_mask:0xf
  v_add_f32_dpp v17, v17, v17 quad_perm:[1,0,3,2] row_mask:0xf bank_mask:0xf
  v_cndmask_b32 v14, v16, v17, s[82:83]
  s_waitcnt vmcnt(33)
  v_dot2_f32_bf16 v16, v164, v10, 0
  v_dot2_f32_bf16 v16, v165, v11, v16
  v_dot2_f32_bf16 v16, v166, v12, v16
  v_dot2_f32_bf16 v16, v167, v13, v16
  s_waitcnt vmcnt(32)
  v_dot2_f32_bf16 v17, v168, v10, 0
  v_dot2_f32_bf16 v17, v169, v11, v17
  v_dot2_f32_bf16 v17, v170, v12, v17
  v_dot2_f32_bf16 v17, v171, v13, v17
  buffer_load_dwordx4 v[196:199], v4, s[40:43], 0 offen offset:1280
  s_waitcnt vmcnt(31)
  v_dot2_f32_bf16 v18, v48, v10, 0
  v_dot2_f32_bf16 v18, v49, v11, v18
  v_dot2_f32_bf16 v18, v50, v12, v18
  v_dot2_f32_bf16 v18, v51, v13, v18
  s_waitcnt vmcnt(29)
  v_dot2_f32_bf16 v19, v64, v10, 0
  v_dot2_f32_bf16 v19, v65, v11, v19
  v_dot2_f32_bf16 v19, v66, v12, v19
  v_dot2_f32_bf16 v19, v67, v13, v19
  s_waitcnt vmcnt(28)
  v_dot2_f32_bf16 v20, v76, v10, 0
  v_dot2_f32_bf16 v20, v77, v11, v20
  v_dot2_f32_bf16 v20, v78, v12, v20
  v_dot2_f32_bf16 v20, v79, v13, v20
  s_mov_b32 s78, 49152
  buffer_load_dwordx4 v[80:83], v2, s[32:35], s78 offen offset:0 sc1 nt
  s_waitcnt vmcnt(27)
  v_dot2_f32_bf16 v21, v96, v10, 0
  v_dot2_f32_bf16 v21, v97, v11, v21
  v_dot2_f32_bf16 v21, v98, v12, v21
  v_dot2_f32_bf16 v21, v99, v13, v21
  s_waitcnt vmcnt(25)
  v_dot2_f32_bf16 v22, v112, v10, 0
  v_dot2_f32_bf16 v22, v113, v11, v22
  v_dot2_f32_bf16 v22, v114, v12, v22
  v_dot2_f32_bf16 v22, v115, v13, v22
  s_waitcnt vmcnt(23)
  v_dot2_f32_bf16 v23, v132, v10, 0
  v_dot2_f32_bf16 v23, v133, v11, v23
  v_dot2_f32_bf16 v23, v134, v12, v23
  v_dot2_f32_bf16 v23, v135, v13, v23
  buffer_load_dwordx4 v[200:203], v4, s[40:43], 0 offen offset:1536
  s_waitcnt vmcnt(23)
  v_dot2_f32_bf16 v24, v144, v10, 0
  v_dot2_f32_bf16 v24, v145, v11, v24
  v_dot2_f32_bf16 v24, v146, v12, v24
  v_dot2_f32_bf16 v24, v147, v13, v24
  s_waitcnt vmcnt(21)
  v_dot2_f32_bf16 v25, v160, v10, 0
  v_dot2_f32_bf16 v25, v161, v11, v25
  v_dot2_f32_bf16 v25, v162, v12, v25
  v_dot2_f32_bf16 v25, v163, v13, v25
  s_waitcnt vmcnt(19)
  v_dot2_f32_bf16 v26, v56, v10, 0
  v_dot2_f32_bf16 v26, v57, v11, v26
  v_dot2_f32_bf16 v26, v58, v12, v26
  v_dot2_f32_bf16 v26, v59, v13, v26
  s_mov_b32 s78, 57344
  buffer_load_dwordx4 v[88:91], v2, s[32:35], s78 offen offset:0 sc1 nt
  s_waitcnt vmcnt(19)
  v_dot2_f32_bf16 v27, v252, v10, 0
  v_dot2_f32_bf16 v27, v253, v11, v27
  v_dot2_f32_bf16 v27, v254, v12, v27
  v_dot2_f32_bf16 v27, v255, v13, v27
  s_waitcnt vmcnt(18)
  v_dot2_f32_bf16 v28, v248, v10, 0
  v_dot2_f32_bf16 v28, v249, v11, v28
  v_dot2_f32_bf16 v28, v250, v12, v28
  v_dot2_f32_bf16 v28, v251, v13, v28
  s_waitcnt vmcnt(17)
  v_dot2_f32_bf16 v29, v84, v10, 0
  v_dot2_f32_bf16 v29, v85, v11, v29
  v_dot2_f32_bf16 v29, v86, v12, v29
  v_dot2_f32_bf16 v29, v87, v13, v29
  s_mov_b32 s78, 65536
  buffer_load_dwordx4 v[92:95], v2, s[32:35], s78 offen offset:0 sc1 nt
  s_waitcnt vmcnt(16)
  v_dot2_f32_bf16 v30, v104, v10, 0
  v_dot2_f32_bf16 v30, v105, v11, v30
  v_dot2_f32_bf16 v30, v106, v12, v30
  v_dot2_f32_bf16 v30, v107, v13, v30
  s_waitcnt vmcnt(14)
  v_dot2_f32_bf16 v31, v124, v10, 0
  v_dot2_f32_bf16 v31, v125, v11, v31
  v_dot2_f32_bf16 v31, v126, v12, v31
  v_dot2_f32_bf16 v31, v127, v13, v31
  v_add_f32_dpp v16, v16, v16 row_mirror row_mask:0xf bank_mask:0x3
  v_add_f32_dpp v17, v17, v17 row_mirror row_mask:0xf bank_mask:0x3
  v_add_f32_dpp v18, v18, v18 row_mirror row_mask:0xf bank_mask:0x3
  v_add_f32_dpp v19, v19, v19 row_mirror row_mask:0xf bank_mask:0x3
  v_add_f32_dpp v20, v20, v20 row_mirror row_mask:0xf bank_mask:0x3
  v_add_f32_dpp v21, v21, v21 row_mirror row_mask:0xf bank_mask:0x3
  v_add_f32_dpp v22, v22, v22 row_mirror row_mask:0xf bank_mask:0x3
  v_add_f32_dpp v23, v23, v23 row_mirror row_mask:0xf bank_mask:0x3
  v_add_f32_dpp v16, v24, v24 row_mirror row_mask:0xf bank_mask:0xc
  v_add_f32_dpp v17, v25, v25 row_mirror row_mask:0xf bank_mask:0xc
  v_add_f32_dpp v18, v26, v26 row_mirror row_mask:0xf bank_mask:0xc
  v_add_f32_dpp v19, v27, v27 row_mirror row_mask:0xf bank_mask:0xc
  v_add_f32_dpp v20, v28, v28 row_mirror row_mask:0xf bank_mask:0xc
  v_add_f32_dpp v21, v29, v29 row_mirror row_mask:0xf bank_mask:0xc
  v_add_f32_dpp v22, v30, v30 row_mirror row_mask:0xf bank_mask:0xc
  v_add_f32_dpp v23, v31, v31 row_mirror row_mask:0xf bank_mask:0xc
  v_add_f32_dpp v16, v16, v16 row_half_mirror row_mask:0xf bank_mask:0x5
  v_add_f32_dpp v17, v17, v17 row_half_mirror row_mask:0xf bank_mask:0x5
  v_add_f32_dpp v18, v18, v18 row_half_mirror row_mask:0xf bank_mask:0x5
  v_add_f32_dpp v19, v19, v19 row_half_mirror row_mask:0xf bank_mask:0x5
  v_add_f32_dpp v16, v20, v20 row_half_mirror row_mask:0xf bank_mask:0xa
  v_add_f32_dpp v17, v21, v21 row_half_mirror row_mask:0xf bank_mask:0xa
  v_add_f32_dpp v18, v22, v22 row_half_mirror row_mask:0xf bank_mask:0xa
  v_add_f32_dpp v19, v23, v23 row_half_mirror row_mask:0xf bank_mask:0xa
  v_add_f32_dpp v16, v16, v16 quad_perm:[3,2,1,0] row_mask:0xf bank_mask:0xf
  v_add_f32_dpp v17, v17, v17 quad_perm:[3,2,1,0] row_mask:0xf bank_mask:0xf
  v_add_f32_dpp v18, v18, v18 quad_perm:[3,2,1,0] row_mask:0xf bank_mask:0xf
  v_add_f32_dpp v19, v19, v19 quad_perm:[3,2,1,0] row_mask:0xf bank_mask:0xf
  v_cndmask_b32 v16, v16, v18, s[80:81]
  v_cndmask_b32 v17, v17, v19, s[80:81]
  s_nop 0
  v_add_f32_dpp v16, v16, v16 quad_perm:[1,0,3,2] row_mask:0xf bank_mask:0xf
  v_add_f32_dpp v17, v17, v17 quad_perm:[1,0,3,2] row_mask:0xf bank_mask:0xf
  v_cndmask_b32 v15, v16, v17, s[82:83]
  v_cvt_pk_bf16_f32 v16, v14, v15
  v_lshlrev_b32 v14, 16, v16
  v_and_b32 v15, 0xffff0000, v16
  v_mul_f32 v14, 0x3db504f3, v14
  v_mul_f32 v15, 0x3db504f3, v15
  v_cvt_pk_bf16_f32 v16, v14, v15
  v_lshlrev_b32 v14, 16, v16
  v_and_b32 v15, 0xffff0000, v16
  v_max_f32 v16, v14, v15
  s_nop 1
  v_max_f32_dpp v16, v16, v16 quad_perm:[1,0,3,2] row_mask:0xf bank_mask:0xf
  s_nop 1
  v_max_f32_dpp v16, v16, v16 quad_perm:[2,3,0,1] row_mask:0xf bank_mask:0xf
  s_nop 1
  v_max_f32_dpp v16, v16, v16 row_half_mirror row_mask:0xf bank_mask:0xf
  s_nop 1
  v_max_f32_dpp v16, v16, v16 row_mirror row_mask:0xf bank_mask:0xf
  s_nop 1
  v_max_f32_dpp v16, v16, v16 row_bcast:15 row_mask:0xa bank_mask:0xf
  s_nop 1
  v_max_f32_dpp v16, v16, v16 row_bcast:31 row_mask:0xc bank_mask:0xf
  s_nop 0
  v_readlane_b32 s84, v16, 63
  s_nop 1
  v_subrev_f32 v16, s84, v14
  v_subrev_f32 v17, s84, v15
  v_mul_f32 v16, 0x3fb8aa3b, v16
  v_mul_f32 v17, 0x3fb8aa3b, v17
  v_exp_f32 v16, v16
  v_exp_f32 v17, v17
  s_nop 0
  v_add_f32 v16, v16, v17
  s_nop 1
  v_add_f32_dpp v16, v16, v16 quad_perm:[1,0,3,2] row_mask:0xf bank_mask:0xf
  s_nop 1
  v_add_f32_dpp v16, v16, v16 quad_perm:[2,3,0,1] row_mask:0xf bank_mask:0xf
  s_nop 1
  v_add_f32_dpp v16, v16, v16 row_half_mirror row_mask:0xf bank_mask:0xf
  s_nop 1
  v_add_f32_dpp v16, v16, v16 row_mirror row_mask:0xf bank_mask:0xf
  s_nop 1
  v_add_f32_dpp v16, v16, v16 row_bcast:15 row_mask:0xa bank_mask:0xf
  s_nop 1
  v_add_f32_dpp v16, v16, v16 row_bcast:31 row_mask:0xc bank_mask:0xf
  s_nop 0
  v_readlane_b32 s85, v16, 63
  v_mov_b32 v16, s84
  s_nop 0
  v_mov_b32 v17, s85
  v_lshlrev_b32 v18, 3, v44
  s_mov_b64 exec, 1
  ds_write_b64 v18, v[16:17] offset:6144
  s_mov_b64 exec, -1
  v_and_b32 v18, 7, v0
  v_lshlrev_b32 v18, 3, v18
  s_waitcnt lgkmcnt(0)
  s_barrier
  ds_read_b64 v[16:17], v18 offset:6144
  s_waitcnt lgkmcnt(0)
  v_mov_b32 v18, v16
  s_nop 1
  v_max_f32_dpp v18, v18, v18 quad_perm:[1,0,3,2] row_mask:0xf bank_mask:0xf
  s_nop 1
  v_max_f32_dpp v18, v18, v18 quad_perm:[2,3,0,1] row_mask:0xf bank_mask:0xf
  s_nop 1
  v_max_f32_dpp v18, v18, v18 row_half_mirror row_mask:0xf bank_mask:0xf
  v_sub_f32 v16, v16, v18
  v_mul_f32 v16, 0x3fb8aa3b, v16
  v_exp_f32 v16, v16
  s_nop 0
  v_mul_f32 v16, v16, v17
  s_nop 1
  v_add_f32_dpp v16, v16, v16 quad_perm:[1,0,3,2] row_mask:0xf bank_mask:0xf
  s_nop 1
  v_add_f32_dpp v16, v16, v16 quad_perm:[2,3,0,1] row_mask:0xf bank_mask:0xf
  s_nop 1
  v_add_f32_dpp v16, v16, v16 row_half_mirror row_mask:0xf bank_mask:0xf
  v_rcp_f32 v16, v16
  v_sub_f32 v14, v14, v18
  v_sub_f32 v15, v15, v18
  v_mul_f32 v14, 0x3fb8aa3b, v14
  v_mul_f32 v15, 0x3fb8aa3b, v15
  v_exp_f32 v14, v14
  v_exp_f32 v15, v15
  v_mul_f32 v14, v14, v16
  v_mul_f32 v15, v15, v16
  v_cvt_pk_bf16_f32 v14, v14, v14
  v_cvt_pk_bf16_f32 v15, v15, v15
  v_lshrrev_b32 v16, 2, v46
  v_lshlrev_b32 v16, 10, v16
  v_lshl_add_u32 v16, v44, 6, v16
  v_lshl_add_u32 v16, v45, 4, v16
  v_and_b32 v17, 3, v0
  v_lshl_add_u32 v16, v17, 2, v16
  v_mul_u32_u24 v18, 2560, v44
  v_lshl_add_u32 v18, v46, 5, v18
  v_lshl_add_u32 v18, v45, 4, v18
  v_bfe_u32 v19, v0, 2, 6
  v_mul_u32_u24 v19, 5, v19
  v_lshrrev_b32 v20, 8, v0
  v_mul_u32_u24 v20, 3, v20
  v_add3_u32 v19, v19, v20, v17
  v_lshlrev_b32 v19, 3, v19
  v_lshlrev_b32 v20, 2, v0
  v_mov_b32 v21, 0
  v_mov_b32 v22, 1
  s_and_b32 s77, s2, 7
  s_lshl_b32 s75, s77, 7
  s_add_u32 s75, s75, 65536
  s_mov_b32 s86, 0x88888888
  s_mov_b32 s87, 0x88888888
  v_mov_b32_dpp v27, v6 row_ror:8 row_mask:0xf bank_mask:0xf
  v_mov_b32_dpp v28, v7 row_ror:8 row_mask:0xf bank_mask:0xf
  v_mov_b32_dpp v29, v8 row_ror:8 row_mask:0xf bank_mask:0xf
  v_mov_b32_dpp v30, v9 row_ror:8 row_mask:0xf bank_mask:0xf
  v_mul_u32_u24 v31, 2560, v44
  v_lshl_add_u32 v31, v1, 4, v31
  v_and_b32 v11, 0xe0c, v19
  v_bfe_u32 v10, v19, 4, 1
  v_lshl_add_u32 v11, v10, 8, v11
  v_bfe_u32 v10, v19, 5, 4
  v_lshl_add_u32 v19, v10, 4, v11
  v_mul_u32_u24 v5, 80, v44
  v_lshrrev_b32 v11, 3, v1
  v_add_u32 v5, v5, v11
  v_mul_u32_u24 v5, 3456, v5
  v_and_b32 v11, 2, v11
  v_and_b32 v10, 7, v0
  v_xor_b32 v11, v10, v11
  v_lshl_add_u32 v25, v11, 4, v5
  v_xor_b32 v11, 4, v11
  v_lshl_add_u32 v26, v11, 4, v5
  s_mul_i32 s3, s26, 10240
  s_add_u32 s3, s3, 46080
  s_lshr_b32 s84, s2, 3
  s_cmp_ge_u32 s26, 4
  s_cselect_b32 s52, s18, s16
  s_cselect_b32 s53, s19, s17
  s_mov_b32 s54, 2211840
  s_mov_b32 s55, 0x20000
  v_mov_b32 v12, 0x7fffff00
  s_cbranch_scc1 L_pf2
  s_and_b32 s85, s84, 7
  s_mul_i32 s85, s85, 80
  v_lshrrev_b32 v23, 1, v0
  v_add_u32 v23, s85, v23
  v_mul_u32_u24 v23, 3456, v23
  v_and_b32 v13, 1, v0
  v_lshl_add_u32 v23, v13, 6, v23
  s_and_b32 s85, s84, 0x18
  s_add_u32 s85, s85, s77
  s_cmp_lt_u32 s85, 27
  s_cselect_b32 s84, 160, 0
  s_lshl_b32 s85, s85, 7
  v_add_u32 v23, s85, v23
  v_cmp_gt_u32 vcc, s84, v0
  s_nop 1
  v_cndmask_b32 v23, v12, v23, vcc
  s_branch L_pfdone
L_pf2:
  s_mul_i32 s84, s84, 54
  v_bfe_u32 v23, v0, 2, 6
  v_add_u32 v23, s84, v23
  v_mul_u32_u24 v23, 1280, v23
  v_lshl_add_u32 v23, v17, 6, v23
  s_mul_i32 s85, s77, 160
  s_and_b32 s85, s85, 0xff80
  v_add_u32 v23, s85, v23
  v_cmp_gt_u32 vcc, 472, v0
  s_nop 1
  v_cndmask_b32 v23, v12, v23, vcc
L_pfdone:
  s_cmp_eq_u32 s26, 7
  s_cselect_b32 s11, s75, 0x7ffff000
  v_and_b32_dpp v32, v14, v6 row_newbcast:0 row_mask:0xf bank_mask:0xf
  v_and_b32_dpp v33, v14, v7 row_newbcast:0 row_mask:0xf bank_mask:0xf
  v_and_b32_dpp v34, v14, v8 row_newbcast:0 row_mask:0xf bank_mask:0xf
  v_and_b32_dpp v35, v14, v9 row_newbcast:0 row_mask:0xf bank_mask:0xf
  buffer_load_dwordx4 v[204:207], v4, s[40:43], 0 offen offset:1792
  s_mov_b32 s78, 73728
  buffer_load_dwordx4 v[100:103], v2, s[32:35], s78 offen offset:0 sc1 nt
  buffer_load_dwordx4 v[208:211], v4, s[40:43], 0 offen offset:2048
  s_mov_b32 s78, 81920
  buffer_load_dwordx4 v[108:111], v2, s[32:35], s78 offen offset:0 sc1 nt
  s_mov_b32 s78, 90112
  buffer_load_dwordx4 v[116:119], v2, s[32:35], s78 offen offset:0 sc1 nt
  buffer_load_dwordx4 v[212:215], v4, s[40:43], 0 offen offset:2304
  s_mov_b32 s78, 98304
  buffer_load_dwordx4 v[120:123], v2, s[32:35], s78 offen offset:0 sc1 nt
  s_mov_b32 s78, 106496
  buffer_load_dwordx4 v[128:131], v2, s[32:35], s78 offen offset:0 sc1 nt
  buffer_load_dwordx4 v[216:219], v4, s[40:43], 0 offen offset:2560
  s_mov_b32 s78, 114688
  buffer_load_dwordx4 v[136:139], v2, s[32:35], s78 offen offset:0 sc1 nt
  buffer_load_dwordx4 v[220:223], v4, s[40:43], 0 offen offset:2816
  s_mov_b32 s78, 122880
  buffer_load_dwordx4 v[140:143], v2, s[32:35], s78 offen offset:0 sc1 nt
  s_mov_b32 s78, 131072
  buffer_load_dwordx4 v[148:151], v2, s[32:35], s78 offen offset:0 sc1 nt
  buffer_load_dwordx4 v[224:227], v4, s[40:43], 0 offen offset:3072
  s_mov_b32 s78, 139264
  buffer_load_dwordx4 v[156:159], v2, s[32:35], s78 offen offset:0 sc1 nt
  buffer_load_dwordx4 v[228:231], v4, s[40:43], 0 offen offset:3328
  s_mov_b32 s78, 147456
  buffer_load_dwordx4 v[164:167], v2, s[32:35], s78 offen offset:0 sc1 nt
  s_mov_b32 s78, 155648
  buffer_load_dwordx4 v[168:171], v2, s[32:35], s78 offen offset:0 sc1 nt
  buffer_load_dwordx4 v[232:235], v4, s[40:43], 0 offen offset:3584
  s_mov_b32 s78, 163840
  buffer_load_dwordx4 v[48:51], v2, s[32:35], s78 offen offset:0 sc1 nt
  s_mov_b32 s78, 172032
  buffer_load_dwordx4 v[64:67], v2, s[32:35], s78 offen offset:0 sc1 nt
  buffer_load_dwordx4 v[236:239], v4, s[40:43], 0 offen offset:3840
  s_mov_b32 s78, 180224
  buffer_load_dwordx4 v[76:79], v2, s[32:35], s78 offen offset:0 sc1 nt
  buffer_load_dwordx4 v[240:243], v4, s[40:43], s68 offen offset:0
  s_mov_b32 s78, 188416
  buffer_load_dwordx4 v[96:99], v2, s[32:35], s78 offen offset:0 sc1 nt
  s_mov_b32 s78, 196608
  buffer_load_dwordx4 v[112:115], v2, s[32:35], s78 offen offset:0 sc1 nt
  buffer_load_dwordx4 v[244:247], v4, s[40:43], s68 offen offset:256
  s_waitcnt vmcnt(40)
  v_mfma_f32_16x16x32_bf16 v[40:43], v[32:35], v[152:155], 0
  v_and_b32_dpp v36, v14, v6 row_newbcast:1 row_mask:0xf bank_mask:0xf
  v_and_b32_dpp v37, v14, v7 row_newbcast:1 row_mask:0xf bank_mask:0xf
  v_and_b32_dpp v38, v14, v8 row_newbcast:1 row_mask:0xf bank_mask:0xf
  v_and_b32_dpp v39, v14, v9 row_newbcast:1 row_mask:0xf bank_mask:0xf
  s_mov_b32 s78, 204800
  buffer_load_dwordx4 v[132:135], v2, s[32:35], s78 offen offset:0 sc1 nt
  buffer_load_dwordx4 v[248:251], v4, s[40:43], s68 offen offset:512
  s_waitcnt vmcnt(40)
  v_mfma_f32_16x16x32_bf16 v[40:43], v[36:39], v[172:175], v[40:43]
  v_and_b32_dpp v32, v14, v6 row_newbcast:2 row_mask:0xf bank_mask:0xf
  v_and_b32_dpp v33, v14, v7 row_newbcast:2 row_mask:0xf bank_mask:0xf
  v_and_b32_dpp v34, v14, v8 row_newbcast:2 row_mask:0xf bank_mask:0xf
  v_and_b32_dpp v35, v14, v9 row_newbcast:2 row_mask:0xf bank_mask:0xf
  s_mov_b32 s78, 212992
  buffer_load_dwordx4 v[144:147], v2, s[32:35], s78 offen offset:0 sc1 nt
  s_mov_b32 s78, 221184
  buffer_load_dwordx4 v[160:163], v2, s[32:35], s78 offen offset:0 sc1 nt
  s_waitcnt vmcnt(40)
  v_mfma_f32_16x16x32_bf16 v[40:43], v[32:35], v[52:55], v[40:43]
  v_and_b32_dpp v36, v14, v6 row_newbcast:3 row_mask:0xf bank_mask:0xf
  v_and_b32_dpp v37, v14, v7 row_newbcast:3 row_mask:0xf bank_mask:0xf
  v_and_b32_dpp v38, v14, v8 row_newbcast:3 row_mask:0xf bank_mask:0xf
  v_and_b32_dpp v39, v14, v9 row_newbcast:3 row_mask:0xf bank_mask:0xf
  buffer_load_dwordx4 v[252:255], v4, s[40:43], s68 offen offset:768
  s_waitcnt vmcnt(40)
  v_mfma_f32_16x16x32_bf16 v[40:43], v[36:39], v[60:63], v[40:43]
  v_and_b32_dpp v32, v14, v6 row_newbcast:4 row_mask:0xf bank_mask:0xf
  v_and_b32_dpp v33, v14, v7 row_newbcast:4 row_mask:0xf bank_mask:0xf
  v_and_b32_dpp v34, v14, v8 row_newbcast:4 row_mask:0xf bank_mask:0xf
  v_and_b32_dpp v35, v14, v9 row_newbcast:4 row_mask:0xf bank_mask:0xf
  s_mov_b32 s78, 229376
  buffer_load_dwordx4 v[56:59], v2, s[32:35], s78 offen offset:0 sc1 nt
  s_mov_b32 s78, 237568
  buffer_load_dwordx4 v[84:87], v2, s[32:35], s78 offen offset:0 sc1 nt
  s_waitcnt vmcnt(40)
  v_mfma_f32_16x16x32_bf16 v[40:43], v[32:35], v[68:71], v[40:43]
  v_and_b32_dpp v36, v14, v6 row_newbcast:5 row_mask:0xf bank_mask:0xf
  v_and_b32_dpp v37, v14, v7 row_newbcast:5 row_mask:0xf bank_mask:0xf
  v_and_b32_dpp v38, v14, v8 row_newbcast:5 row_mask:0xf bank_mask:0xf
  v_and_b32_dpp v39, v14, v9 row_newbcast:5 row_mask:0xf bank_mask:0xf
  s_mov_b32 s78, 245760
  buffer_load_dwordx4 v[104:107], v2, s[32:35], s78 offen offset:0 sc1 nt
  s_waitcnt vmcnt(40)
  v_mfma_f32_16x16x32_bf16 v[40:43], v[36:39], v[72:75], v[40:43]
  v_and_b32_dpp v32, v14, v6 row_newbcast:6 row_mask:0xf bank_mask:0xf
  v_and_b32_dpp v33, v14, v7 row_newbcast:6 row_mask:0xf bank_mask:0xf
  v_and_b32_dpp v34, v14, v8 row_newbcast:6 row_mask:0xf bank_mask:0xf
  v_and_b32_dpp v35, v14, v9 row_newbcast:6 row_mask:0xf bank_mask:0xf
  s_mov_b32 s78, 253952
  buffer_load_dwordx4 v[124:127], v2, s[32:35], s78 offen offset:0 sc1 nt
  s_waitcnt vmcnt(39)
  v_mfma_f32_16x16x32_bf16 v[40:43], v[32:35], v[80:83], v[40:43]
  v_and_b32_dpp v36, v14, v6 row_newbcast:7 row_mask:0xf bank_mask:0xf
  v_and_b32_dpp v37, v14, v7 row_newbcast:7 row_mask:0xf bank_mask:0xf
  v_and_b32_dpp v38, v14, v8 row_newbcast:7 row_mask:0xf bank_mask:0xf
  v_and_b32_dpp v39, v14, v9 row_newbcast:7 row_mask:0xf bank_mask:0xf
  s_waitcnt vmcnt(37)
  s_nop 0
  v_mfma_f32_16x16x32_bf16 v[40:43], v[36:39], v[88:91], v[40:43]
  v_and_b32_dpp v32, v14, v6 row_newbcast:8 row_mask:0xf bank_mask:0xf
  v_and_b32_dpp v33, v14, v7 row_newbcast:8 row_mask:0xf bank_mask:0xf
  v_and_b32_dpp v34, v14, v8 row_newbcast:8 row_mask:0xf bank_mask:0xf
  v_and_b32_dpp v35, v14, v9 row_newbcast:8 row_mask:0xf bank_mask:0xf
  s_waitcnt vmcnt(36)
  s_nop 0
  v_mfma_f32_16x16x32_bf16 v[40:43], v[32:35], v[92:95], v[40:43]
  v_and_b32_dpp v36, v14, v6 row_newbcast:9 row_mask:0xf bank_mask:0xf
  v_and_b32_dpp v37, v14, v7 row_newbcast:9 row_mask:0xf bank_mask:0xf
  v_and_b32_dpp v38, v14, v8 row_newbcast:9 row_mask:0xf bank_mask:0xf
  v_and_b32_dpp v39, v14, v9 row_newbcast:9 row_mask:0xf bank_mask:0xf
  s_waitcnt vmcnt(34)
  s_nop 0
  v_mfma_f32_16x16x32_bf16 v[40:43], v[36:39], v[100:103], v[40:43]
  v_and_b32_dpp v32, v14, v6 row_newbcast:10 row_mask:0xf bank_mask:0xf
  v_and_b32_dpp v33, v14, v7 row_newbcast:10 row_mask:0xf bank_mask:0xf
  v_and_b32_dpp v34, v14, v8 row_newbcast:10 row_mask:0xf bank_mask:0xf
  v_and_b32_dpp v35, v14, v9 row_newbcast:10 row_mask:0xf bank_mask:0xf
  s_waitcnt vmcnt(32)
  s_nop 0
  v_mfma_f32_16x16x32_bf16 v[40:43], v[32:35], v[108:111], v[40:43]
  v_and_b32_dpp v36, v14, v6 row_newbcast:11 row_mask:0xf bank_mask:0xf
  v_and_b32_dpp v37, v14, v7 row_newbcast:11 row_mask:0xf bank_mask:0xf
  v_and_b32_dpp v38, v14, v8 row_newbcast:11 row_mask:0xf bank_mask:0xf
  v_and_b32_dpp v39, v14, v9 row_newbcast:11 row_mask:0xf bank_mask:0xf
  s_waitcnt vmcnt(31)
  s_nop 0
  v_mfma_f32_16x16x32_bf16 v[40:43], v[36:39], v[116:119], v[40:43]
  v_and_b32_dpp v32, v14, v6 row_newbcast:12 row_mask:0xf bank_mask:0xf
  v_and_b32_dpp v33, v14, v7 row_newbcast:12 row_mask:0xf bank_mask:0xf
  v_and_b32_dpp v34, v14, v8 row_newbcast:12 row_mask:0xf bank_mask:0xf
  v_and_b32_dpp v35, v14, v9 row_newbcast:12 row_mask:0xf bank_mask:0xf
  s_waitcnt vmcnt(29)
  s_nop 0
  v_mfma_f32_16x16x32_bf16 v[40:43], v[32:35], v[120:123], v[40:43]
  v_and_b32_dpp v36, v14, v6 row_newbcast:13 row_mask:0xf bank_mask:0xf
  v_and_b32_dpp v37, v14, v7 row_newbcast:13 row_mask:0xf bank_mask:0xf
  v_and_b32_dpp v38, v14, v8 row_newbcast:13 row_mask:0xf bank_mask:0xf
  v_and_b32_dpp v39, v14, v9 row_newbcast:13 row_mask:0xf bank_mask:0xf
  s_waitcnt vmcnt(28)
  s_nop 0
  v_mfma_f32_16x16x32_bf16 v[40:43], v[36:39], v[128:131], v[40:43]
  v_and_b32_dpp v32, v14, v6 row_newbcast:14 row_mask:0xf bank_mask:0xf
  v_and_b32_dpp v33, v14, v7 row_newbcast:14 row_mask:0xf bank_mask:0xf
  v_and_b32_dpp v34, v14, v8 row_newbcast:14 row_mask:0xf bank_mask:0xf
  v_and_b32_dpp v35, v14, v9 row_newbcast:14 row_mask:0xf bank_mask:0xf
  s_waitcnt vmcnt(26)
  s_nop 0
  v_mfma_f32_16x16x32_bf16 v[40:43], v[32:35], v[136:139], v[40:43]
  v_and_b32_dpp v36, v14, v6 row_newbcast:15 row_mask:0xf bank_mask:0xf
  v_and_b32_dpp v37, v14, v7 row_newbcast:15 row_mask:0xf bank_mask:0xf
  v_and_b32_dpp v38, v14, v8 row_newbcast:15 row_mask:0xf bank_mask:0xf
  v_and_b32_dpp v39, v14, v9 row_newbcast:15 row_mask:0xf bank_mask:0xf
  s_waitcnt vmcnt(24)
  s_nop 0
  v_mfma_f32_16x16x32_bf16 v[40:43], v[36:39], v[140:143], v[40:43]
  v_and_b32_dpp v32, v15, v6 row_newbcast:0 row_mask:0xf bank_mask:0xf
  v_and_b32_dpp v33, v15, v7 row_newbcast:0 row_mask:0xf bank_mask:0xf
  v_and_b32_dpp v34, v15, v8 row_newbcast:0 row_mask:0xf bank_mask:0xf
  v_and_b32_dpp v35, v15, v9 row_newbcast:0 row_mask:0xf bank_mask:0xf
  s_waitcnt vmcnt(23)
  s_nop 0
  v_mfma_f32_16x16x32_bf16 v[40:43], v[32:35], v[148:151], v[40:43]
  s_load_dword s89, s[22:23], 0
  v_and_b32_dpp v36, v15, v6 row_newbcast:1 row_mask:0xf bank_mask:0xf
  v_and_b32_dpp v37, v15, v7 row_newbcast:1 row_mask:0xf bank_mask:0xf
  v_and_b32_dpp v38, v15, v8 row_newbcast:1 row_mask:0xf bank_mask:0xf
  v_and_b32_dpp v39, v15, v9 row_newbcast:1 row_mask:0xf bank_mask:0xf
  s_waitcnt vmcnt(21)
  s_nop 0
  v_mfma_f32_16x16x32_bf16 v[40:43], v[36:39], v[156:159], v[40:43]
  v_and_b32_dpp v32, v15, v6 row_newbcast:2 row_mask:0xf bank_mask:0xf
  v_and_b32_dpp v33, v15, v7 row_newbcast:2 row_mask:0xf bank_mask:0xf
  v_and_b32_dpp v34, v15, v8 row_newbcast:2 row_mask:0xf bank_mask:0xf
  v_and_b32_dpp v35, v15, v9 row_newbcast:2 row_mask:0xf bank_mask:0xf
  s_waitcnt vmcnt(19)
  s_nop 0
  v_mfma_f32_16x16x32_bf16 v[40:43], v[32:35], v[164:167], v[40:43]
  v_and_b32_dpp v36, v15, v6 row_newbcast:3 row_mask:0xf bank_mask:0xf
  v_and_b32_dpp v37, v15, v7 row_newbcast:3 row_mask:0xf bank_mask:0xf
  v_and_b32_dpp v38, v15, v8 row_newbcast:3 row_mask:0xf bank_mask:0xf
  v_and_b32_dpp v39, v15, v9 row_newbcast:3 row_mask:0xf bank_mask:0xf
  s_waitcnt vmcnt(18)
  s_nop 0
  v_mfma_f32_16x16x32_bf16 v[40:43], v[36:39], v[168:171], v[40:43]
  v_and_b32_dpp v32, v15, v6 row_newbcast:4 row_mask:0xf bank_mask:0xf
  v_and_b32_dpp v33, v15, v7 row_newbcast:4 row_mask:0xf bank_mask:0xf
  v_and_b32_dpp v34, v15, v8 row_newbcast:4 row_mask:0xf bank_mask:0xf
  v_and_b32_dpp v35, v15, v9 row_newbcast:4 row_mask:0xf bank_mask:0xf
  s_waitcnt vmcnt(16)
  s_nop 0
  v_mfma_f32_16x16x32_bf16 v[40:43], v[32:35], v[48:51], v[40:43]
  s_waitcnt lgkmcnt(0)
  s_cmp_ge_u32 s89, 8
  s_cbranch_scc0 L_initslow
L_initok:
  v_and_b32_dpp v36, v15, v6 row_newbcast:5 row_mask:0xf bank_mask:0xf
  v_and_b32_dpp v37, v15, v7 row_newbcast:5 row_mask:0xf bank_mask:0xf
  v_and_b32_dpp v38, v15, v8 row_newbcast:5 row_mask:0xf bank_mask:0xf
  v_and_b32_dpp v39, v15, v9 row_newbcast:5 row_mask:0xf bank_mask:0xf
  s_mov_b64 exec, 1
  buffer_atomic_add v22, v21, s[48:51], s11 offen sc0 sc1
  s_mov_b64 exec, -1
  s_waitcnt vmcnt(16)
  v_mfma_f32_16x16x32_bf16 v[40:43], v[36:39], v[64:67], v[40:43]
  v_and_b32_dpp v32, v15, v6 row_newbcast:6 row_mask:0xf bank_mask:0xf
  v_and_b32_dpp v33, v15, v7 row_newbcast:6 row_mask:0xf bank_mask:0xf
  v_and_b32_dpp v34, v15, v8 row_newbcast:6 row_mask:0xf bank_mask:0xf
  v_and_b32_dpp v35, v15, v9 row_newbcast:6 row_mask:0xf bank_mask:0xf
  s_waitcnt vmcnt(14)
  s_nop 0
  v_mfma_f32_16x16x32_bf16 v[40:43], v[32:35], v[76:79], v[40:43]
  v_and_b32_dpp v36, v15, v6 row_newbcast:7 row_mask:0xf bank_mask:0xf
  v_and_b32_dpp v37, v15, v7 row_newbcast:7 row_mask:0xf bank_mask:0xf
  v_and_b32_dpp v38, v15, v8 row_newbcast:7 row_mask:0xf bank_mask:0xf
  v_and_b32_dpp v39, v15, v9 row_newbcast:7 row_mask:0xf bank_mask:0xf
  s_waitcnt vmcnt(12)
  s_nop 0
  v_mfma_f32_16x16x32_bf16 v[40:43], v[36:39], v[96:99], v[40:43]
  v_and_b32_dpp v32, v15, v6 row_newbcast:8 row_mask:0xf bank_mask:0xf
  v_and_b32_dpp v33, v15, v7 row_newbcast:8 row_mask:0xf bank_mask:0xf
  v_and_b32_dpp v34, v15, v8 row_newbcast:8 row_mask:0xf bank_mask:0xf
  v_and_b32_dpp v35, v15, v9 row_newbcast:8 row_mask:0xf bank_mask:0xf
  s_waitcnt vmcnt(11)
  s_nop 0
  v_mfma_f32_16x16x32_bf16 v[40:43], v[32:35], v[112:115], v[40:43]
  v_and_b32_dpp v36, v15, v6 row_newbcast:9 row_mask:0xf bank_mask:0xf
  v_and_b32_dpp v37, v15, v7 row_newbcast:9 row_mask:0xf bank_mask:0xf
  v_and_b32_dpp v38, v15, v8 row_newbcast:9 row_mask:0xf bank_mask:0xf
  v_and_b32_dpp v39, v15, v9 row_newbcast:9 row_mask:0xf bank_mask:0xf
  s_waitcnt vmcnt(9)
  s_nop 0
  v_mfma_f32_16x16x32_bf16 v[40:43], v[36:39], v[132:135], v[40:43]
  v_and_b32_dpp v32, v15, v6 row_newbcast:10 row_mask:0xf bank_mask:0xf
  v_and_b32_dpp v33, v15, v7 row_newbcast:10 row_mask:0xf bank_mask:0xf
  v_and_b32_dpp v34, v15, v8 row_newbcast:10 row_mask:0xf bank_mask:0xf
  v_and_b32_dpp v35, v15, v9 row_newbcast:10 row_mask:0xf bank_mask:0xf
  s_waitcnt vmcnt(7)
  s_nop 0
  v_mfma_f32_16x16x32_bf16 v[40:43], v[32:35], v[144:147], v[40:43]
  v_and_b32_dpp v36, v15, v6 row_newbcast:11 row_mask:0xf bank_mask:0xf
  v_and_b32_dpp v37, v15, v7 row_newbcast:11 row_mask:0xf bank_mask:0xf
  v_and_b32_dpp v38, v15, v8 row_newbcast:11 row_mask:0xf bank_mask:0xf
  v_and_b32_dpp v39, v15, v9 row_newbcast:11 row_mask:0xf bank_mask:0xf
  s_waitcnt vmcnt(6)
  s_nop 0
  v_mfma_f32_16x16x32_bf16 v[40:43], v[36:39], v[160:163], v[40:43]
  v_and_b32_dpp v32, v15, v6 row_newbcast:12 row_mask:0xf bank_mask:0xf
  v_and_b32_dpp v33, v15, v7 row_newbcast:12 row_mask:0xf bank_mask:0xf
  v_and_b32_dpp v34, v15, v8 row_newbcast:12 row_mask:0xf bank_mask:0xf
  v_and_b32_dpp v35, v15, v9 row_newbcast:12 row_mask:0xf bank_mask:0xf
  s_waitcnt vmcnt(4)
  s_nop 0
  v_mfma_f32_16x16x32_bf16 v[40:43], v[32:35], v[56:59], v[40:43]
  v_and_b32_dpp v36, v15, v6 row_newbcast:13 row_mask:0xf bank_mask:0xf
  v_and_b32_dpp v37, v15, v7 row_newbcast:13 row_mask:0xf bank_mask:0xf
  v_and_b32_dpp v38, v15, v8 row_newbcast:13 row_mask:0xf bank_mask:0xf
  v_and_b32_dpp v39, v15, v9 row_newbcast:13 row_mask:0xf bank_mask:0xf
  s_waitcnt vmcnt(3)
  s_nop 0
  v_mfma_f32_16x16x32_bf16 v[40:43], v[36:39], v[84:87], v[40:43]
  v_and_b32_dpp v32, v15, v6 row_newbcast:14 row_mask:0xf bank_mask:0xf
  v_and_b32_dpp v33, v15, v7 row_newbcast:14 row_mask:0xf bank_mask:0xf
  v_and_b32_dpp v34, v15, v8 row_newbcast:14 row_mask:0xf bank_mask:0xf
  v_and_b32_dpp v35, v15, v9 row_newbcast:14 row_mask:0xf bank_mask:0xf
  s_waitcnt vmcnt(2)
  s_nop 0
  v_mfma_f32_16x16x32_bf16 v[40:43], v[32:35], v[104:107], v[40:43]
  v_and_b32_dpp v36, v15, v6 row_newbcast:15 row_mask:0xf bank_mask:0xf
  v_and_b32_dpp v37, v15, v7 row_newbcast:15 row_mask:0xf bank_mask:0xf
  v_and_b32_dpp v38, v15, v8 row_newbcast:15 row_mask:0xf bank_mask:0xf
  v_and_b32_dpp v39, v15, v9 row_newbcast:15 row_mask:0xf bank_mask:0xf
  s_waitcnt vmcnt(1)
  s_nop 0
  v_mfma_f32_16x16x32_bf16 v[40:43], v[36:39], v[124:127], v[40:43]
  s_mov_b32 exec_hi, 0
  s_nop 6
  ds_write_b128 v47, v[40:43] offset:0
  s_mov_b64 exec, -1
  s_waitcnt lgkmcnt(0)
  s_barrier
  ds_read2st64_b32 v[10:11], v16 offset0:0 offset1:2
  s_waitcnt lgkmcnt(0)
  v_add_f32 v10, v10, v11
  s_nop 1
  v_add_f32_dpp v10, v10, v10 row_ror:4 row_mask:0xf bank_mask:0xf
  s_nop 1
  v_add_f32_dpp v10, v10, v10 row_ror:8 row_mask:0xf bank_mask:0xf
  v_cvt_pk_bf16_f32 v10, v10, v10
  s_nop 1
  v_and_b32_dpp v48, v10, v6 row_newbcast:0 row_mask:0xf bank_mask:0xf
  v_and_b32_dpp v49, v10, v7 row_newbcast:0 row_mask:0xf bank_mask:0xf
  v_and_b32_dpp v50, v10, v8 row_newbcast:0 row_mask:0xf bank_mask:0xf
  v_and_b32_dpp v51, v10, v9 row_newbcast:0 row_mask:0xf bank_mask:0xf
  v_and_b32_dpp v52, v10, v27 row_newbcast:0 row_mask:0xf bank_mask:0xf
  v_and_b32_dpp v53, v10, v28 row_newbcast:0 row_mask:0xf bank_mask:0xf
  v_and_b32_dpp v54, v10, v29 row_newbcast:0 row_mask:0xf bank_mask:0xf
  v_and_b32_dpp v55, v10, v30 row_newbcast:0 row_mask:0xf bank_mask:0xf
  v_mfma_f32_16x16x32_bf16 v[128:131], v[48:51], v[176:179], 0
  v_and_b32_dpp v56, v10, v6 row_newbcast:1 row_mask:0xf bank_mask:0xf
  v_and_b32_dpp v57, v10, v7 row_newbcast:1 row_mask:0xf bank_mask:0xf
  v_mfma_f32_16x16x32_bf16 v[132:135], v[48:51], v[184:187], 0
  v_and_b32_dpp v58, v10, v8 row_newbcast:1 row_mask:0xf bank_mask:0xf
  v_and_b32_dpp v59, v10, v9 row_newbcast:1 row_mask:0xf bank_mask:0xf
  v_mfma_f32_16x16x32_bf16 v[136:139], v[48:51], v[192:195], 0
  v_and_b32_dpp v60, v10, v27 row_newbcast:1 row_mask:0xf bank_mask:0xf
  v_and_b32_dpp v61, v10, v28 row_newbcast:1 row_mask:0xf bank_mask:0xf
  v_mfma_f32_16x16x32_bf16 v[128:131], v[52:55], v[180:183], v[128:131]
  v_and_b32_dpp v62, v10, v29 row_newbcast:1 row_mask:0xf bank_mask:0xf
  v_and_b32_dpp v63, v10, v30 row_newbcast:1 row_mask:0xf bank_mask:0xf
  v_mfma_f32_16x16x32_bf16 v[132:135], v[52:55], v[188:191], v[132:135]
  v_mfma_f32_16x16x32_bf16 v[128:131], v[56:59], v[196:199], v[128:131]
  v_and_b32_dpp v64, v10, v6 row_newbcast:2 row_mask:0xf bank_mask:0xf
  v_and_b32_dpp v65, v10, v7 row_newbcast:2 row_mask:0xf bank_mask:0xf
  v_mfma_f32_16x16x32_bf16 v[132:135], v[56:59], v[204:207], v[132:135]
  v_and_b32_dpp v66, v10, v8 row_newbcast:2 row_mask:0xf bank_mask:0xf
  v_and_b32_dpp v67, v10, v9 row_newbcast:2 row_mask:0xf bank_mask:0xf
  v_mfma_f32_16x16x32_bf16 v[136:139], v[56:59], v[212:215], v[136:139]
  v_and_b32_dpp v68, v10, v27 row_newbcast:2 row_mask:0xf bank_mask:0xf
  v_and_b32_dpp v69, v10, v28 row_newbcast:2 row_mask:0xf bank_mask:0xf
  v_mfma_f32_16x16x32_bf16 v[128:131], v[60:63], v[200:203], v[128:131]
  v_and_b32_dpp v70, v10, v29 row_newbcast:2 row_mask:0xf bank_mask:0xf
  v_and_b32_dpp v71, v10, v30 row_newbcast:2 row_mask:0xf bank_mask:0xf
  v_mfma_f32_16x16x32_bf16 v[132:135], v[60:63], v[208:211], v[132:135]
  v_mfma_f32_16x16x32_bf16 v[128:131], v[64:67], v[216:219], v[128:131]
  v_and_b32_dpp v72, v10, v6 row_newbcast:3 row_mask:0xf bank_mask:0xf
  v_and_b32_dpp v73, v10, v7 row_newbcast:3 row_mask:0xf bank_mask:0xf
  v_mfma_f32_16x16x32_bf16 v[132:135], v[64:67], v[224:227], v[132:135]
  v_and_b32_dpp v74, v10, v8 row_newbcast:3 row_mask:0xf bank_mask:0xf
  v_and_b32_dpp v75, v10, v9 row_newbcast:3 row_mask:0xf bank_mask:0xf
  v_mfma_f32_16x16x32_bf16 v[136:139], v[64:67], v[232:235], v[136:139]
  v_and_b32_dpp v76, v10, v27 row_newbcast:3 row_mask:0xf bank_mask:0xf
  v_and_b32_dpp v77, v10, v28 row_newbcast:3 row_mask:0xf bank_mask:0xf
  v_mfma_f32_16x16x32_bf16 v[128:131], v[68:71], v[220:223], v[128:131]
  v_and_b32_dpp v78, v10, v29 row_newbcast:3 row_mask:0xf bank_mask:0xf
  v_and_b32_dpp v79, v10, v30 row_newbcast:3 row_mask:0xf bank_mask:0xf
  v_mfma_f32_16x16x32_bf16 v[132:135], v[68:71], v[228:231], v[132:135]
  v_mfma_f32_16x16x32_bf16 v[128:131], v[72:75], v[236:239], v[128:131]
  v_mfma_f32_16x16x32_bf16 v[132:135], v[72:75], v[244:247], v[132:135]
  v_mfma_f32_16x16x32_bf16 v[136:139], v[72:75], v[252:255], v[136:139]
  v_mfma_f32_16x16x32_bf16 v[128:131], v[76:79], v[240:243], v[128:131]
  v_mfma_f32_16x16x32_bf16 v[132:135], v[76:79], v[248:251], v[132:135]
  s_mov_b32 exec_hi, 0
  s_nop 4
  ds_write_b128 v31, v[136:139] offset:8448
  s_mov_b64 exec, -1
  ds_write_b128 v31, v[128:131] offset:6400
  ds_write_b128 v31, v[132:135] offset:7424
  buffer_load_dword v24, v23, s[52:55], 0 offen
  s_lshl_b32 s84, s76, 12
  s_waitcnt lgkmcnt(0)
  s_barrier
  ds_read_b64 v[148:149], v19 offset:6400
  ds_read_b64 v[150:151], v19 offset:8960
  ds_read_b64 v[152:153], v19 offset:11520
  ds_read_b64 v[154:155], v19 offset:14080
  ds_read_b64 v[156:157], v19 offset:16640
  ds_read_b64 v[158:159], v19 offset:19200
  ds_read_b64 v[160:161], v19 offset:21760
  ds_read_b64 v[162:163], v19 offset:24320
  s_waitcnt lgkmcnt(3)
  v_pk_add_f32 v[148:149], v[148:149], v[156:157]
  s_waitcnt lgkmcnt(2)
  v_pk_add_f32 v[150:151], v[150:151], v[158:159]
  s_waitcnt lgkmcnt(1)
  v_pk_add_f32 v[152:153], v[152:153], v[160:161]
  s_waitcnt lgkmcnt(0)
  v_pk_add_f32 v[154:155], v[154:155], v[162:163]
  v_pk_add_f32 v[148:149], v[148:149], v[152:153]
  v_pk_add_f32 v[150:151], v[150:151], v[154:155]
  v_pk_add_f32 v[148:149], v[148:149], v[150:151]
  v_cndmask_b32 v10, v148, 1.0, s[86:87]
  v_cndmask_b32 v11, v149, 1.0, s[86:87]
  buffer_atomic_add_f32 v10, v20, s[48:51], s84 offen
  buffer_atomic_add_f32 v11, v20, s[48:51], s84 offen offset:2048
  s_mov_b32 s27, 99
  s_waitcnt vmcnt(3)
  s_cmp_lg_u32 s26, 7
  s_cbranch_scc1 L_notk2
  s_mov_b64 exec, 1
  ds_write_b32 v21, v22 offset:6208
  s_mov_b64 exec, -1
  s_waitcnt lgkmcnt(0)
L_notk2:
  s_barrier
  ds_read_b32 v12, v21 offset:6208
  s_waitcnt lgkmcnt(0)
  v_readfirstlane_b32 s79, v12
  s_nop 0
  s_cmp_ge_u32 s79, 9
  s_cbranch_scc1 L_fin
  s_mov_b32 s54, 2211840
  s_mov_b32 s55, 0x20000
  s_mov_b32 s85, 0x42000000
  s_mov_b32 s88, 0
  v_and_b32 v10, 7, v0
  s_mul_i32 s27, s77, 5
  s_add_u32 s27, s27, s79
  s_cmp_lt_u32 s79, 5
  s_cbranch_scc1 L_ffn2
  s_lshl_b32 s27, s79, 3
  s_add_u32 s27, s27, s77
  s_cmp_ge_u32 s27, 67
  s_cbranch_scc1 L_fin
  s_sub_u32 s79, s27, 40
  s_mov_b32 s52, s16
  s_mov_b32 s53, s17
  s_lshl_b32 s13, s79, 7
  s_mov_b32 m0, s3
  s_nop 0
  buffer_load_dwordx4 v25, s[52:55], s13 offen  lds
  s_add_u32 s3, s3, 1024
  s_add_u32 s13, s13, 27648
  s_mov_b32 m0, s3
  s_nop 0
  buffer_load_dwordx4 v26, s[52:55], s13 offen  lds
  s_add_u32 s3, s3, 1024
  s_add_u32 s13, s13, 27648
  s_mov_b32 m0, s3
  s_nop 0
  buffer_load_dwordx4 v25, s[52:55], s13 offen  lds
  s_add_u32 s3, s3, 1024
  s_add_u32 s13, s13, 27648
  s_mov_b32 m0, s3
  s_nop 0
  buffer_load_dwordx4 v26, s[52:55], s13 offen  lds
  s_add_u32 s3, s3, 1024
  s_add_u32 s13, s13, 27648
  s_mov_b32 m0, s3
  s_nop 0
  buffer_load_dwordx4 v25, s[52:55], s13 offen  lds
  s_add_u32 s3, s3, 1024
  s_add_u32 s13, s13, 27648
  s_mov_b32 m0, s3
  s_nop 0
  buffer_load_dwordx4 v26, s[52:55], s13 offen  lds
  s_add_u32 s3, s3, 1024
  s_add_u32 s13, s13, 27648
  s_mov_b32 m0, s3
  s_nop 0
  buffer_load_dwordx4 v25, s[52:55], s13 offen  lds
  s_add_u32 s3, s3, 1024
  s_add_u32 s13, s13, 27648
  s_mov_b32 m0, s3
  s_nop 0
  buffer_load_dwordx4 v26, s[52:55], s13 offen  lds
  s_add_u32 s3, s3, 1024
  s_add_u32 s13, s13, 27648
  s_mov_b32 m0, s3
  s_nop 0
  buffer_load_dwordx4 v25, s[52:55], s13 offen  lds
  s_add_u32 s3, s3, 1024
  s_add_u32 s13, s13, 27648
  s_mov_b32 m0, s3
  s_nop 0
  buffer_load_dwordx4 v26, s[52:55], s13 offen  lds
  v_mul_u32_u24 v23, 20, v1
  v_mul_u32_u24 v21, 1280, v44
  v_add_u32 v21, v21, v23
  buffer_load_dwordx4 v[248:251], v21, s[44:47], 0 offen
  buffer_load_dword v252, v21, s[44:47], 0 offen offset:16
  v_lshlrev_b32 v22, 12, v44
  v_lshl_add_u32 v22, v1, 4, v22
  v_mul_u32_u24 v11, 1312, v44
  v_add_u32 v23, v23, v11
  v_add_u32 v35, 27136, v23
  v_mul_u32_u24 v29, 1312, v10
  v_lshl_add_u32 v29, v45, 4, v29
  v_lshlrev_b32 v30, 4, v10
  v_and_b32 v11, 1, v44
  v_lshl_add_u32 v30, v11, 9, v30
  v_bfe_u32 v11, v44, 1, 1
  v_lshl_add_u32 v30, v11, 7, v30
  v_lshrrev_b32 v11, 1, v45
  v_lshl_add_u32 v30, v11, 8, v30
  v_and_b32 v11, 1, v45
  v_lshl_add_u32 v30, v11, 3, v30
  v_lshrrev_b32 v12, 2, v46
  v_lshl_add_u32 v12, v45, 3, v12
  v_lshlrev_b32 v12, 7, v12
  v_lshrrev_b32 v13, 3, v46
  v_lshl_add_u32 v13, v11, 1, v13
  v_and_b32 v11, 3, v44
  v_xor_b32 v11, v11, v13
  v_lshl_add_u32 v12, v11, 5, v12
  v_lshl_add_u32 v12, v17, 3, v12
  v_add_u32 v12, 46080, v12
  v_add_u32 v13, 40960, v12
  s_waitcnt vmcnt(0)
  s_barrier
  s_cmp_ge_u32 s26, 4
  s_cbranch_scc1 L_notr
  ds_read_b64_tr_b16 v[48:49], v12 offset:0
  ds_read_b64_tr_b16 v[50:51], v12 offset:512
  ds_read_b64_tr_b16 v[52:53], v12 offset:4096
  ds_read_b64_tr_b16 v[54:55], v12 offset:4608
  ds_read_b64_tr_b16 v[56:57], v12 offset:8192
  ds_read_b64_tr_b16 v[58:59], v12 offset:8704
  ds_read_b64_tr_b16 v[60:61], v12 offset:12288
  ds_read_b64_tr_b16 v[62:63], v12 offset:12800
  ds_read_b64_tr_b16 v[64:65], v12 offset:16384
  ds_read_b64_tr_b16 v[66:67], v12 offset:16896
  ds_read_b64_tr_b16 v[68:69], v12 offset:20480
  ds_read_b64_tr_b16 v[70:71], v12 offset:20992
  ds_read_b64_tr_b16 v[72:73], v12 offset:24576
  ds_read_b64_tr_b16 v[74:75], v12 offset:25088
  ds_read_b64_tr_b16 v[76:77], v12 offset:28672
  ds_read_b64_tr_b16 v[78:79], v12 offset:29184
  ds_read_b64_tr_b16 v[80:81], v12 offset:32768
  ds_read_b64_tr_b16 v[82:83], v12 offset:33280
  ds_read_b64_tr_b16 v[84:85], v12 offset:36864
  ds_read_b64_tr_b16 v[86:87], v12 offset:37376
  ds_read_b64_tr_b16 v[88:89], v13 offset:0
  ds_read_b64_tr_b16 v[90:91], v13 offset:512
  ds_read_b64_tr_b16 v[92:93], v13 offset:4096
  ds_read_b64_tr_b16 v[94:95], v13 offset:4608
  ds_read_b64_tr_b16 v[96:97], v13 offset:8192
  ds_read_b64_tr_b16 v[98:99], v13 offset:8704
  ds_read_b64_tr_b16 v[100:101], v13 offset:12288
  ds_read_b64_tr_b16 v[102:103], v13 offset:12800
  ds_read_b64_tr_b16 v[104:105], v13 offset:16384
  ds_read_b64_tr_b16 v[106:107], v13 offset:16896
  ds_read_b64_tr_b16 v[108:109], v13 offset:20480
  ds_read_b64_tr_b16 v[110:111], v13 offset:20992
  ds_read_b64_tr_b16 v[112:113], v13 offset:24576
  ds_read_b64_tr_b16 v[114:115], v13 offset:25088
  ds_read_b64_tr_b16 v[116:117], v13 offset:28672
  ds_read_b64_tr_b16 v[118:119], v13 offset:29184
  ds_read_b64_tr_b16 v[120:121], v13 offset:32768
  ds_read_b64_tr_b16 v[122:123], v13 offset:33280
  ds_read_b64_tr_b16 v[124:125], v13 offset:36864
  ds_read_b64_tr_b16 v[126:127], v13 offset:37376
L_notr:
  buffer_load_dwordx4 v[220:223], v22, s[48:51], 0 offen offset:0 sc0 sc1
  buffer_load_dwordx4 v[224:227], v22, s[48:51], 0 offen offset:1024 sc0 sc1
  buffer_load_dwordx4 v[228:231], v22, s[48:51], 0 offen offset:2048 sc0 sc1
  buffer_load_dwordx4 v[232:235], v22, s[48:51], 0 offen offset:3072 sc0 sc1
  v_lshlrev_b32 v208, 16, v248
  v_and_b32 v209, 0xffff0000, v248
  v_lshlrev_b32 v210, 16, v249
  v_and_b32 v211, 0xffff0000, v249
  v_lshlrev_b32 v212, 16, v250
  v_and_b32 v213, 0xffff0000, v250
  v_lshlrev_b32 v214, 16, v251
  v_and_b32 v215, 0xffff0000, v251
  v_lshlrev_b32 v216, 16, v252
  v_and_b32 v217, 0xffff0000, v252
  s_mov_b32 s78, 1
  s_branch L_poll1_chk
L_poll1:
  buffer_load_dwordx4 v[220:223], v22, s[48:51], 0 offen offset:0 sc0 sc1
  buffer_load_dwordx4 v[224:227], v22, s[48:51], 0 offen offset:1024 sc0 sc1
  buffer_load_dwordx4 v[228:231], v22, s[48:51], 0 offen offset:2048 sc0 sc1
  buffer_load_dwordx4 v[232:235], v22, s[48:51], 0 offen offset:3072 sc0 sc1
L_poll1_chk:
  s_add_u32 s88, s88, 1
  s_waitcnt vmcnt(0)
  v_min_f32 v31, v223, v227
  v_min3_f32 v31, v31, v231, v235
  v_cmp_ne_u32 vcc, s85, v31
  s_cmp_gt_u32 s88, 400000
  s_cbranch_scc1 L_poll1_done
  s_nop 2
  s_cbranch_vccnz L_poll1
L_poll1_done:
L_f1_body:
  v_cvt_pk_bf16_f32 v24, v220, v228
  v_cvt_pk_bf16_f32 v25, v221, v229
  v_cvt_pk_bf16_f32 v26, v222, v230
  v_cvt_pk_bf16_f32 v27, v224, v232
  v_cvt_pk_bf16_f32 v28, v225, v233
  v_lshlrev_b32 v220, 16, v24
  v_and_b32 v221, 0xffff0000, v24
  v_lshlrev_b32 v222, 16, v25
  v_and_b32 v223, 0xffff0000, v25
  v_lshlrev_b32 v224, 16, v26
  v_and_b32 v225, 0xffff0000, v26
  v_lshlrev_b32 v226, 16, v27
  v_and_b32 v227, 0xffff0000, v27
  v_lshlrev_b32 v228, 16, v28
  v_and_b32 v229, 0xffff0000, v28
  v_pk_add_f32 v[220:221], v[220:221], v[208:209]
  v_pk_add_f32 v[222:223], v[222:223], v[210:211]
  v_pk_add_f32 v[224:225], v[224:225], v[212:213]
  v_pk_add_f32 v[226:227], v[226:227], v[214:215]
  v_pk_add_f32 v[228:229], v[228:229], v[216:217]
  v_cvt_pk_bf16_f32 v24, v220, v221
  v_cvt_pk_bf16_f32 v25, v222, v223
  v_cvt_pk_bf16_f32 v26, v224, v225
  v_cvt_pk_bf16_f32 v27, v226, v227
  v_cvt_pk_bf16_f32 v28, v228, v229
  v_lshlrev_b32 v238, 16, v24
  v_and_b32 v239, 0xffff0000, v24
  v_lshlrev_b32 v240, 16, v25
  v_and_b32 v241, 0xffff0000, v25
  v_readfirstlane_b32 s10, v238
  v_lshlrev_b32 v242, 16, v26
  v_and_b32 v243, 0xffff0000, v26
  v_lshlrev_b32 v244, 16, v27
  v_and_b32 v245, 0xffff0000, v27
  v_lshlrev_b32 v246, 16, v28
  v_and_b32 v247, 0xffff0000, v28
  s_mov_b32 s11, s10
  v_pk_add_f32 v[220:221], v[238:239], s[10:11] neg_lo:[0,1] neg_hi:[0,1]
  v_pk_add_f32 v[222:223], v[240:241], s[10:11] neg_lo:[0,1] neg_hi:[0,1]
  v_pk_add_f32 v[224:225], v[242:243], s[10:11] neg_lo:[0,1] neg_hi:[0,1]
  v_pk_add_f32 v[226:227], v[244:245], s[10:11] neg_lo:[0,1] neg_hi:[0,1]
  v_pk_add_f32 v[228:229], v[246:247], s[10:11] neg_lo:[0,1] neg_hi:[0,1]
  v_pk_add_f32 v[36:37], v[220:221], v[222:223]
  v_pk_mul_f32 v[38:39], v[220:221], v[220:221]
  v_pk_fma_f32 v[38:39], v[222:223], v[222:223], v[38:39]
  v_pk_add_f32 v[36:37], v[36:37], v[224:225]
  v_pk_fma_f32 v[38:39], v[224:225], v[224:225], v[38:39]
  v_pk_add_f32 v[36:37], v[36:37], v[226:227]
  v_pk_fma_f32 v[38:39], v[226:227], v[226:227], v[38:39]
  v_pk_add_f32 v[36:37], v[36:37], v[228:229]
  v_pk_fma_f32 v[38:39], v[228:229], v[228:229], v[38:39]
  v_add_f32 v32, v36, v37
  v_add_f32 v33, v38, v39
  s_nop 0
  v_add_f32_dpp v32, v32, v32 quad_perm:[1,0,3,2] row_mask:0xf bank_mask:0xf
  v_add_f32_dpp v33, v33, v33 quad_perm:[1,0,3,2] row_mask:0xf bank_mask:0xf
  s_nop 0
  v_add_f32_dpp v32, v32, v32 quad_perm:[2,3,0,1] row_mask:0xf bank_mask:0xf
  v_add_f32_dpp v33, v33, v33 quad_perm:[2,3,0,1] row_mask:0xf bank_mask:0xf
  s_nop 0
  v_add_f32_dpp v32, v32, v32 row_half_mirror row_mask:0xf bank_mask:0xf
  v_add_f32_dpp v33, v33, v33 row_half_mirror row_mask:0xf bank_mask:0xf
  s_nop 0
  v_add_f32_dpp v32, v32, v32 row_mirror row_mask:0xf bank_mask:0xf
  v_add_f32_dpp v33, v33, v33 row_mirror row_mask:0xf bank_mask:0xf
  s_nop 0
  v_add_f32_dpp v32, v32, v32 row_bcast:15 row_mask:0xa bank_mask:0xf
  v_add_f32_dpp v33, v33, v33 row_bcast:15 row_mask:0xa bank_mask:0xf
  s_nop 0
  v_add_f32_dpp v32, v32, v32 row_bcast:31 row_mask:0xc bank_mask:0xf
  v_add_f32_dpp v33, v33, v33 row_bcast:31 row_mask:0xc bank_mask:0xf
  v_mov_b32 v36, 0x3acccccd
  v_readlane_b32 s84, v32, 63
  v_readlane_b32 s12, v33, 63
  s_nop 0
  v_mul_f32 v37, s84, v36
  v_mul_f32 v32, s12, v36
  v_add_f32 v38, s10, v37
  v_fma_f32 v32, -v37, v37, v32
  v_max_f32 v32, 0, v32
  v_cvt_pk_bf16_f32 v32, v32, v38
  v_and_b32 v38, 0xffff0000, v32
  v_lshlrev_b32 v32, 16, v32
  v_add_f32 v32, 0x3727c5ac, v32
  v_mov_b32 v39, v38
  v_cvt_pk_bf16_f32 v32, v32, v32
  v_pk_add_f32 v[238:239], v[238:239], v[38:39] neg_lo:[0,1] neg_hi:[0,1]
  v_pk_add_f32 v[240:241], v[240:241], v[38:39] neg_lo:[0,1] neg_hi:[0,1]
  v_lshlrev_b32 v32, 16, v32
  v_sqrt_f32 v32, v32
  v_pk_add_f32 v[242:243], v[242:243], v[38:39] neg_lo:[0,1] neg_hi:[0,1]
  v_pk_add_f32 v[244:245], v[244:245], v[38:39] neg_lo:[0,1] neg_hi:[0,1]
  v_pk_add_f32 v[246:247], v[246:247], v[38:39] neg_lo:[0,1] neg_hi:[0,1]
  v_cvt_pk_bf16_f32 v32, v32, v32
  v_cvt_pk_bf16_f32 v24, v238, v239
  v_cvt_pk_bf16_f32 v25, v240, v241
  v_cvt_pk_bf16_f32 v26, v242, v243
  v_cvt_pk_bf16_f32 v27, v244, v245
  v_cvt_pk_bf16_f32 v28, v246, v247
  v_lshlrev_b32 v32, 16, v32
  v_rcp_f32 v36, v32
  v_lshlrev_b32 v238, 16, v24
  v_and_b32 v239, 0xffff0000, v24
  v_lshlrev_b32 v240, 16, v25
  v_and_b32 v241, 0xffff0000, v25
  v_lshlrev_b32 v242, 16, v26
  v_and_b32 v243, 0xffff0000, v26
  v_lshlrev_b32 v244, 16, v27
  v_and_b32 v245, 0xffff0000, v27
  v_lshlrev_b32 v246, 16, v28
  v_and_b32 v247, 0xffff0000, v28
  v_mov_b32 v37, v36
  v_pk_mul_f32 v[238:239], v[238:239], v[36:37]
  v_pk_mul_f32 v[240:241], v[240:241], v[36:37]
  v_pk_mul_f32 v[242:243], v[242:243], v[36:37]
  v_pk_mul_f32 v[244:245], v[244:245], v[36:37]
  v_pk_mul_f32 v[246:247], v[246:247], v[36:37]
  v_cvt_pk_bf16_f32 v24, v238, v239
  v_cvt_pk_bf16_f32 v25, v240, v241
  v_cvt_pk_bf16_f32 v26, v242, v243
  v_cvt_pk_bf16_f32 v27, v244, v245
  v_cvt_pk_bf16_f32 v28, v246, v247
  ds_write2_b32 v35, v24, v25 offset0:0 offset1:1
  ds_write2_b32 v35, v26, v27 offset0:2 offset1:3
  ds_write_b32 v35, v28 offset:16
  s_waitcnt lgkmcnt(0)
  s_barrier
  s_cmp_ge_u32 s26, 4
  s_cbranch_scc1 L_f1_skip
  ds_read_b128 v[128:131], v29 offset:27136
  ds_read_b128 v[132:135], v29 offset:27200
  ds_read_b128 v[136:139], v29 offset:27264
  ds_read_b128 v[140:143], v29 offset:27328
  ds_read_b128 v[144:147], v29 offset:27392
  ds_read_b128 v[148:151], v29 offset:27456
  ds_read_b128 v[152:155], v29 offset:27520
  ds_read_b128 v[156:159], v29 offset:27584
  s_waitcnt lgkmcnt(7)
  v_mfma_f32_16x16x32_bf16 v[40:43], v[48:51], v[128:131], 0
  ds_read_b128 v[160:163], v29 offset:27648
  s_waitcnt lgkmcnt(7)
  v_mfma_f32_16x16x32_bf16 v[40:43], v[52:55], v[132:135], v[40:43]
  ds_read_b128 v[164:167], v29 offset:27712
  s_waitcnt lgkmcnt(7)
  v_mfma_f32_16x16x32_bf16 v[40:43], v[56:59], v[136:139], v[40:43]
  ds_read_b128 v[168:171], v29 offset:27776
  s_waitcnt lgkmcnt(7)
  v_mfma_f32_16x16x32_bf16 v[40:43], v[60:63], v[140:143], v[40:43]
  ds_read_b128 v[172:175], v29 offset:27840
  s_waitcnt lgkmcnt(7)
  v_mfma_f32_16x16x32_bf16 v[40:43], v[64:67], v[144:147], v[40:43]
  ds_read_b128 v[176:179], v29 offset:27904
  s_waitcnt lgkmcnt(7)
  v_mfma_f32_16x16x32_bf16 v[40:43], v[68:71], v[148:151], v[40:43]
  ds_read_b128 v[180:183], v29 offset:27968
  s_waitcnt lgkmcnt(7)
  v_mfma_f32_16x16x32_bf16 v[40:43], v[72:75], v[152:155], v[40:43]
  ds_read_b128 v[184:187], v29 offset:28032
  s_waitcnt lgkmcnt(7)
  v_mfma_f32_16x16x32_bf16 v[40:43], v[76:79], v[156:159], v[40:43]
  ds_read_b128 v[188:191], v29 offset:28096
  s_waitcnt lgkmcnt(7)
  v_mfma_f32_16x16x32_bf16 v[40:43], v[80:83], v[160:163], v[40:43]
  ds_read_b128 v[192:195], v29 offset:28160
  s_waitcnt lgkmcnt(7)
  v_mfma_f32_16x16x32_bf16 v[40:43], v[84:87], v[164:167], v[40:43]
  ds_read_b128 v[196:199], v29 offset:28224
  s_waitcnt lgkmcnt(7)
  v_mfma_f32_16x16x32_bf16 v[40:43], v[88:91], v[168:171], v[40:43]
  ds_read_b128 v[200:203], v29 offset:28288
  s_waitcnt lgkmcnt(7)
  v_mfma_f32_16x16x32_bf16 v[40:43], v[92:95], v[172:175], v[40:43]
  ds_read_b128 v[204:207], v29 offset:28352
  s_waitcnt lgkmcnt(7)
  v_mfma_f32_16x16x32_bf16 v[40:43], v[96:99], v[176:179], v[40:43]
  s_waitcnt lgkmcnt(6)
  v_mfma_f32_16x16x32_bf16 v[40:43], v[100:103], v[180:183], v[40:43]
  s_waitcnt lgkmcnt(5)
  v_mfma_f32_16x16x32_bf16 v[40:43], v[104:107], v[184:187], v[40:43]
  s_waitcnt lgkmcnt(4)
  v_mfma_f32_16x16x32_bf16 v[40:43], v[108:111], v[188:191], v[40:43]
  s_waitcnt lgkmcnt(3)
  v_mfma_f32_16x16x32_bf16 v[40:43], v[112:115], v[192:195], v[40:43]
  s_waitcnt lgkmcnt(2)
  v_mfma_f32_16x16x32_bf16 v[40:43], v[116:119], v[196:199], v[40:43]
  s_waitcnt lgkmcnt(1)
  v_mfma_f32_16x16x32_bf16 v[40:43], v[120:123], v[200:203], v[40:43]
  s_waitcnt lgkmcnt(0)
  v_mfma_f32_16x16x32_bf16 v[40:43], v[124:127], v[204:207], v[40:43]
  s_lshl_b32 s84, s79, 10
  s_nop 6
  v_max_f32 v40, 0, v40
  v_max_f32 v41, 0, v41
  v_max_f32 v42, 0, v42
  v_max_f32 v43, 0, v43
  v_cvt_pk_bf16_f32 v36, v40, v41
  v_cvt_pk_bf16_f32 v38, v40, v41
  v_cvt_pk_bf16_f32 v37, v42, v43
  v_cvt_pk_bf16_f32 v39, v42, v43
  v_permlane16_swap_b32 v36, v38
  s_nop 0
  v_permlane16_swap_b32 v37, v39
  s_mov_b32 exec_lo, 0xff
  s_mov_b32 exec_hi, 0xff
  buffer_store_dwordx4 v[36:39], v30, s[60:63], s84 offen sc0 sc1
L_f1_nost:
  s_mov_b64 exec, -1
L_f1_skip:
  s_endpgm
L_ffn2:
  s_mov_b32 s52, s18
  s_mov_b32 s53, s19
  s_lshl_b32 s13, s27, 5
  s_mov_b32 s79, s13
  v_lshrrev_b32 v5, 1, v1
  v_lshl_add_u32 v5, v44, 6, v5
  v_mul_u32_u24 v5, 1280, v5
  v_and_b32 v11, 1, v0
  v_lshl_add_u32 v5, v11, 4, v5
  s_mov_b32 m0, s3
  s_nop 0
  buffer_load_dwordx4 v5, s[52:55], s13 offen  lds
  s_add_u32 s3, s3, 1024
  s_add_u32 s13, s13, 40960
  s_mov_b32 m0, s3
  s_nop 0
  buffer_load_dwordx4 v5, s[52:55], s13 offen  lds
  s_add_u32 s3, s3, 1024
  s_add_u32 s13, s13, 614400
  s_mov_b32 m0, s3
  s_nop 0
  buffer_load_dwordx4 v5, s[52:55], s13 offen  lds
  s_add_u32 s3, s3, 1024
  s_add_u32 s13, s13, 40960
  s_mov_b32 m0, s3
  s_nop 0
  buffer_load_dwordx4 v5, s[52:55], s13 offen  lds
  s_add_u32 s3, s3, 1024
  s_add_u32 s13, s13, 614400
  s_mov_b32 m0, s3
  s_nop 0
  buffer_load_dwordx4 v5, s[52:55], s13 offen  lds
  s_add_u32 s3, s3, 1024
  s_add_u32 s13, s13, 40960
  s_mov_b32 m0, s3
  s_nop 0
  buffer_load_dwordx4 v5, s[52:55], s13 offen  lds
  s_add_u32 s3, s3, 1024
  s_add_u32 s13, s13, 614400
  s_mov_b32 m0, s3
  s_nop 0
  buffer_load_dwordx4 v5, s[52:55], s13 offen  lds
  s_add_u32 s3, s3, 1024
  s_add_u32 s13, s13, 40960
  s_mov_b32 m0, s3
  s_nop 0
  buffer_load_dwordx4 v5, s[52:55], s13 offen  lds
  v_mul_u32_u24 v21, 1280, v10
  v_lshl_add_u32 v21, v45, 3, v21
  buffer_load_dwordx2 v[24:25], v21, s[44:47], s79 offen
  v_mul_u32_u24 v12, 10240, v44
  v_lshl_add_u32 v12, v45, 8, v12
  v_lshl_add_u32 v12, v46, 3, v12
  v_add_u32 v12, 46080, v12
  v_lshlrev_b32 v22, 4, v0
  v_lshlrev_b32 v16, 4, v0
  v_lshlrev_b32 v17, 4, v1
  v_bfe_u32 v11, v0, 3, 1
  v_mul_u32_u24 v11, 3968, v11
  v_add_u32 v17, v17, v11
  s_mov_b32 s78, 1
  s_cmp_lg_u32 s26, 0
  s_cbranch_scc1 L_ffn2_noh
  s_lshl_b32 s84, s27, 4
  v_lshlrev_b32 v11, 2, v45
  v_add_u32 v11, s84, v11
  v_add_u32 v13, 0, v11
  v_mul_u32_u24 v29, 205, v13
  v_lshrrev_b32 v29, 11, v29
  v_mul_u32_u24 v30, 10, v29
  v_sub_u32 v13, v13, v30
  v_and_b32 v30, 1, v13
  v_lshrrev_b32 v13, 1, v13
  v_mul_u32_u24 v31, 11, v13
  v_lshrrev_b32 v31, 5, v31
  v_lshl_add_u32 v30, v30, 1, v31
  v_mul_u32_u24 v31, 3, v31
  v_sub_u32 v212, v13, v31
  v_lshl_add_u32 v29, v30, 6, v29
  v_lshlrev_b32 v29, 4, v29
  v_lshl_add_u32 v208, v10, 12, v29
  v_add_u32 v13, 1, v11
  v_mul_u32_u24 v29, 205, v13
  v_lshrrev_b32 v29, 11, v29
  v_mul_u32_u24 v30, 10, v29
  v_sub_u32 v13, v13, v30
  v_and_b32 v30, 1, v13
  v_lshrrev_b32 v13, 1, v13
  v_mul_u32_u24 v31, 11, v13
  v_lshrrev_b32 v31, 5, v31
  v_lshl_add_u32 v30, v30, 1, v31
  v_mul_u32_u24 v31, 3, v31
  v_sub_u32 v213, v13, v31
  v_lshl_add_u32 v29, v30, 6, v29
  v_lshlrev_b32 v29, 4, v29
  v_lshl_add_u32 v209, v10, 12, v29
  v_add_u32 v13, 2, v11
  v_mul_u32_u24 v29, 205, v13
  v_lshrrev_b32 v29, 11, v29
  v_mul_u32_u24 v30, 10, v29
  v_sub_u32 v13, v13, v30
  v_and_b32 v30, 1, v13
  v_lshrrev_b32 v13, 1, v13
  v_mul_u32_u24 v31, 11, v13
  v_lshrrev_b32 v31, 5, v31
  v_lshl_add_u32 v30, v30, 1, v31
  v_mul_u32_u24 v31, 3, v31
  v_sub_u32 v214, v13, v31
  v_lshl_add_u32 v29, v30, 6, v29
  v_lshlrev_b32 v29, 4, v29
  v_lshl_add_u32 v210, v10, 12, v29
  v_add_u32 v13, 3, v11
  v_mul_u32_u24 v29, 205, v13
  v_lshrrev_b32 v29, 11, v29
  v_mul_u32_u24 v30, 10, v29
  v_sub_u32 v13, v13, v30
  v_and_b32 v30, 1, v13
  v_lshrrev_b32 v13, 1, v13
  v_mul_u32_u24 v31, 11, v13
  v_lshrrev_b32 v31, 5, v31
  v_lshl_add_u32 v30, v30, 1, v31
  v_mul_u32_u24 v31, 3, v31
  v_sub_u32 v215, v13, v31
  v_lshl_add_u32 v29, v30, 6, v29
  v_lshlrev_b32 v29, 4, v29
  v_lshl_add_u32 v211, v10, 12, v29
  v_lshlrev_b32 v29, 12, v10
  s_and_b32 s84, s27, 31
  s_lshl_b32 s84, s84, 7
  v_add_u32 v29, s84, v29
  s_mov_b32 s84, 0x42000000
  s_mov_b64 exec, 0xff
L_light2:
  buffer_load_dword v30, v29, s[48:51], 0 offen offset:12 sc0 sc1
  s_add_u32 s88, s88, 1
  s_waitcnt vmcnt(0)
  v_cmp_gt_f32 vcc, s84, v30
  s_cmp_gt_u32 s88, 400000
  s_cbranch_scc1 L_light2_done
  s_nop 2
  s_cbranch_vccnz L_light2
L_light2_done:
  s_mov_b64 exec, -1
L_poll2h:
  buffer_load_dwordx4 v[220:223], v208, s[48:51], 0 offen sc0 sc1
  buffer_load_dwordx4 v[224:227], v209, s[48:51], 0 offen sc0 sc1
  buffer_load_dwordx4 v[228:231], v210, s[48:51], 0 offen sc0 sc1
  buffer_load_dwordx4 v[232:235], v211, s[48:51], 0 offen sc0 sc1
  s_add_u32 s88, s88, 1
  s_waitcnt vmcnt(0)
  v_min_f32 v31, v223, v227
  v_min3_f32 v31, v31, v231, v235
  v_cmp_ne_u32 vcc, s85, v31
  s_cmp_gt_u32 s88, 400000
  s_cbranch_scc1 L_poll2h_done
  s_nop 2
  s_cbranch_vccnz L_poll2h
L_poll2h_done:
  v_cmp_eq_u32 vcc, 1, v212
  s_nop 1
  v_cndmask_b32 v220, v220, v221, vcc
  v_cmp_eq_u32 vcc, 2, v212
  s_nop 1
  v_cndmask_b32 v220, v220, v222, vcc
  v_cmp_eq_u32 vcc, 1, v213
  s_nop 1
  v_cndmask_b32 v224, v224, v225, vcc
  v_cmp_eq_u32 vcc, 2, v213
  s_nop 1
  v_cndmask_b32 v224, v224, v226, vcc
  v_cmp_eq_u32 vcc, 1, v214
  s_nop 1
  v_cndmask_b32 v228, v228, v229, vcc
  v_cmp_eq_u32 vcc, 2, v214
  s_nop 1
  v_cndmask_b32 v228, v228, v230, vcc
  v_cmp_eq_u32 vcc, 1, v215
  s_nop 1
  v_cndmask_b32 v232, v232, v233, vcc
  v_cmp_eq_u32 vcc, 2, v215
  s_nop 1
  v_cndmask_b32 v232, v232, v234, vcc
  v_cvt_pk_bf16_f32 v31, v220, v224
  v_lshlrev_b32 v32, 16, v31
  v_and_b32 v33, 0xffff0000, v31
  v_lshlrev_b32 v34, 16, v24
  v_and_b32 v35, 0xffff0000, v24
  v_add_f32 v32, v32, v34
  v_add_f32 v33, v33, v35
  v_cvt_pk_bf16_f32 v31, v32, v33
  v_lshlrev_b32 v208, 16, v31
  v_and_b32 v209, 0xffff0000, v31
  v_cvt_pk_bf16_f32 v31, v228, v232
  v_lshlrev_b32 v32, 16, v31
  v_and_b32 v33, 0xffff0000, v31
  v_lshlrev_b32 v34, 16, v25
  v_and_b32 v35, 0xffff0000, v25
  v_add_f32 v32, v32, v34
  v_add_f32 v33, v33, v35
  v_cvt_pk_bf16_f32 v31, v32, v33
  v_lshlrev_b32 v210, 16, v31
  v_and_b32 v211, 0xffff0000, v31
L_ffn2_noh:
  s_waitcnt vmcnt(0)
  ds_read_b64_tr_b16 v[48:49], v12 offset:0
  ds_read_b64_tr_b16 v[50:51], v12 offset:128
  ds_read_b64_tr_b16 v[52:53], v12 offset:1024
  ds_read_b64_tr_b16 v[54:55], v12 offset:1152
  ds_read_b64_tr_b16 v[56:57], v12 offset:2048
  ds_read_b64_tr_b16 v[58:59], v12 offset:2176
  ds_read_b64_tr_b16 v[60:61], v12 offset:3072
  ds_read_b64_tr_b16 v[62:63], v12 offset:3200
  ds_read_b64_tr_b16 v[64:65], v12 offset:4096
  ds_read_b64_tr_b16 v[66:67], v12 offset:4224
  ds_read_b64_tr_b16 v[68:69], v12 offset:5120
  ds_read_b64_tr_b16 v[70:71], v12 offset:5248
  ds_read_b64_tr_b16 v[72:73], v12 offset:6144
  ds_read_b64_tr_b16 v[74:75], v12 offset:6272
  ds_read_b64_tr_b16 v[76:77], v12 offset:7168
  ds_read_b64_tr_b16 v[78:79], v12 offset:7296
  s_barrier
  s_mov_b32 s88, 0
L_poll2:
  buffer_load_dwordx4 v[128:131], v22, s[60:63], 0 offen sc0 sc1
  buffer_load_dwordx4 v[132:135], v22, s[60:63], s69 offen sc0 sc1
  buffer_load_dwordx4 v[136:139], v22, s[60:63], s71 offen sc0 sc1
  buffer_load_dwordx4 v[140:143], v22, s[60:63], s73 offen sc0 sc1
  s_add_u32 s88, s88, 1
  s_waitcnt lgkmcnt(0)
  s_waitcnt vmcnt(3)
  v_mfma_f32_16x16x32_bf16 v[36:39], v[52:55], v[128:131], 0
  v_mfma_f32_16x16x32_bf16 v[40:43], v[48:51], v[128:131], 0
  v_max3_u32 v31, v128, v129, v130
  v_mov_b32 v32, v131
  s_waitcnt vmcnt(2)
  v_mfma_f32_16x16x32_bf16 v[36:39], v[60:63], v[132:135], v[36:39]
  v_mfma_f32_16x16x32_bf16 v[40:43], v[56:59], v[132:135], v[40:43]
  v_max3_u32 v31, v31, v132, v133
  v_max3_u32 v32, v32, v134, v135
  s_waitcnt vmcnt(1)
  v_mfma_f32_16x16x32_bf16 v[36:39], v[68:71], v[136:139], v[36:39]
  v_mfma_f32_16x16x32_bf16 v[40:43], v[64:67], v[136:139], v[40:43]
  v_max3_u32 v31, v31, v136, v137
  v_max3_u32 v32, v32, v138, v139
  s_waitcnt vmcnt(0)
  v_mfma_f32_16x16x32_bf16 v[36:39], v[76:79], v[140:143], v[36:39]
  v_mfma_f32_16x16x32_bf16 v[40:43], v[72:75], v[140:143], v[40:43]
  v_max3_u32 v31, v31, v140, v141
  v_max3_u32 v32, v32, v142, v143
  v_max_u32 v31, v31, v32
  v_cmp_eq_u32 vcc, -1, v31
  s_cmp_gt_u32 s88, 400000
  s_cselect_b64 vcc, 0, vcc
  s_nop 2
  s_cbranch_vccnz L_poll2
  v_add_f32_dpp v40, v36, v40 row_ror:8 row_mask:0xf bank_mask:0xf
  v_add_f32_dpp v41, v37, v41 row_ror:8 row_mask:0xf bank_mask:0xf
  v_add_f32_dpp v42, v38, v42 row_ror:8 row_mask:0xf bank_mask:0xf
  v_add_f32_dpp v43, v39, v43 row_ror:8 row_mask:0xf bank_mask:0xf
  ds_write_b128 v16, v[40:43] offset:37888
  s_waitcnt lgkmcnt(0)
  s_barrier
  s_cmp_lg_u32 s26, 0
  s_cbranch_scc1 L_f2_skip
  ds_read_b128 v[48:51], v17 offset:37888
  ds_read_b128 v[52:55], v17 offset:38912
  ds_read_b128 v[56:59], v17 offset:39936
  ds_read_b128 v[60:63], v17 offset:40960
  s_waitcnt lgkmcnt(2)
  v_pk_add_f32 v[48:49], v[48:49], v[52:53]
  v_pk_add_f32 v[50:51], v[50:51], v[54:55]
  s_waitcnt lgkmcnt(0)
  v_pk_add_f32 v[56:57], v[56:57], v[60:61]
  v_pk_add_f32 v[58:59], v[58:59], v[62:63]
  v_pk_add_f32 v[48:49], v[48:49], v[56:57]
  v_pk_add_f32 v[50:51], v[50:51], v[58:59]
  s_nop 0
  v_add_f32_dpp v48, v48, v48 row_ror:8 row_mask:0xf bank_mask:0xf
  v_add_f32_dpp v49, v49, v49 row_ror:8 row_mask:0xf bank_mask:0xf
  v_add_f32_dpp v50, v50, v50 row_ror:8 row_mask:0xf bank_mask:0xf
  v_add_f32_dpp v51, v51, v51 row_ror:8 row_mask:0xf bank_mask:0xf
  s_mov_b32 exec_lo, 0x00ff00ff
  s_mov_b32 exec_hi, 0x00ff00ff
  v_cvt_pk_bf16_f32 v31, v48, v49
  v_lshlrev_b32 v32, 16, v31
  v_and_b32 v33, 0xffff0000, v31
  v_add_f32 v32, v32, v208
  v_add_f32 v33, v33, v209
  v_cvt_pk_bf16_f32 v40, v32, v33
  v_cvt_pk_bf16_f32 v31, v50, v51
  v_lshlrev_b32 v32, 16, v31
  v_and_b32 v33, 0xffff0000, v31
  v_add_f32 v32, v32, v210
  v_add_f32 v33, v33, v211
  v_cvt_pk_bf16_f32 v41, v32, v33
  buffer_store_dwordx2 v[40:41], v21, s[56:59], s79 offen
L_f2_nost:
  s_mov_b64 exec, -1
L_f2_skip:
L_fin:
L_end:
  s_endpgm
L_initslow:
  s_mov_b32 s88, 0
L_initpoll:
  buffer_load_dword v12, v21, s[64:67], 0 offen sc0 sc1
  s_waitcnt vmcnt(0)
  v_readfirstlane_b32 s89, v12
  s_add_u32 s88, s88, 1
  s_cmp_gt_u32 s88, 400000
  s_cbranch_scc1 L_initok
  s_cmp_ge_u32 s89, 8
  s_cbranch_scc0 L_initpoll
  s_branch L_initok
.section .rodata,"a"
.p2align 6
.amdhsa_kernel sequential_preLN__sliding_block_cached__dense_activation_relu__decode_kernel
  .amdhsa_next_free_vgpr 256
  .amdhsa_next_free_sgpr 102
  .amdhsa_accum_offset 256
  .amdhsa_group_segment_fixed_size 0
  .amdhsa_kernarg_size 88
  .amdhsa_user_sgpr_count 2
  .amdhsa_user_sgpr_kernarg_segment_ptr 1
  .amdhsa_system_sgpr_workgroup_id_x 1
  .amdhsa_float_denorm_mode_32 3
.end_amdhsa_kernel
```
